```python
import torch

def _softmax(x, axis=-1):
    return torch.softmax(x, dim=axis)

def _gelu(x):
    return torch.nn.functional.gelu(x, approximate='tanh')

def _silu(x):
    return torch.nn.functional.silu(x)

def _sigmoid(x):
    return torch.sigmoid(x)

def _layernorm(x, axis=-1, eps=1e-05):
    m = x.mean(dim=axis, keepdim=True)
    v = x.var(dim=axis, keepdim=True, unbiased=False)
    return (x - m) / torch.sqrt(v + eps)

def _scatter_add(tgt, idx, src, axis=0):
    return tgt.clone().index_add_(axis, idx, src)

def _segment_sum(src, seg, n):
    out = torch.zeros((n,) + src.shape[1:], dtype=src.dtype)
    return out.index_add_(0, seg, src)

def _pad(x, pw):
    flat = tuple((v for pair in reversed(pw) for v in pair))
    return torch.nn.functional.pad(x, flat)
kernel_name = 'adaLN_cond__sliding_block__glu_gated_glu__prompt'

def setup_inputs():

    _w = lambda a: (lambda t: t.to(torch.bfloat16) if t.is_floating_point() else t)(torch.as_tensor(a))

    def _A_setup():
        B, S, D = (1, 2048, 512)
        return {'x': _w((lambda *s: torch.randn(*s, dtype=torch.bfloat16) * 0.05)(B, S, D)), 'wqkv': _w((lambda *s: torch.randn(*s, dtype=torch.bfloat16) * 0.05)(D, 3 * D)), 'wo': _w((lambda *s: torch.randn(*s, dtype=torch.bfloat16) * 0.05)(D, D))}
    _A_in = _A_setup()

    def _B_setup():
        B, S, D, F = (1, 2048, 512, 1792)
        return {'x': _w((lambda *s: torch.randn(*s, dtype=torch.bfloat16) * 0.05)(B, S, D)), 'w_gate': _w((lambda *s: torch.randn(*s, dtype=torch.bfloat16) * 0.05)(D, F)), 'w_up': _w((lambda *s: torch.randn(*s, dtype=torch.bfloat16) * 0.05)(D, F)), 'w_down': _w((lambda *s: torch.randn(*s, dtype=torch.bfloat16) * 0.05)(F, D))}
    _B_in = _B_setup()
    return {'A_x': _A_in['x'], 'A_wqkv': _A_in['wqkv'], 'A_wo': _A_in['wo'], 'B_x': _B_in['x'], 'B_w_gate': _B_in['w_gate'], 'B_w_up': _B_in['w_up'], 'B_w_down': _B_in['w_down'], 'c': _w((lambda *s: torch.randn(*s, dtype=torch.bfloat16) * 0.1)(1, 512) * 8.0), 'w_mod': _w((lambda *s: torch.randn(*s, dtype=torch.bfloat16) * 0.1)(512, 6 * 512) * 512 ** (-0.5) * 8.0)}

def reference(A_x, A_wqkv, A_wo, B_x, B_w_gate, B_w_up, B_w_down, c, w_mod):

    def _A_ref(x, wqkv, wo):
        B, S, D = x.shape
        H = 32
        Dh = D // H
        W = 256
        qkv = (lambda x, *d: x.permute(*d))((x @ wqkv).reshape(B, S, 3, H, Dh), 2, 0, 3, 1, 4)
        q, k, v = (qkv[0], qkv[1], qkv[2])
        scores = torch.einsum('bhqd,bhkd->bhqk', q, k) * Dh ** (-0.5)
        idx = torch.arange(S)
        mask = (idx[:, None] - idx[None, :] >= 0) & (idx[:, None] - idx[None, :] < W)
        scores = torch.where(mask[None, None], scores, -1000000000.0)
        p = _softmax(scores, axis=-1)
        o = torch.einsum('bhqk,bhkd->bhqd', p, v)
        return (lambda x, *d: x.permute(*d))(o, 0, 2, 1, 3).reshape(B, S, D) @ wo

    def _B_ref(x, w_gate, w_up, w_down):
        g = torch.einsum('bsd,df->bsf', x, w_gate)
        u = torch.einsum('bsd,df->bsf', x, w_up)
        h = _sigmoid(g) * u
        return torch.einsum('bsf,fd->bsd', h, w_down)
    x = A_x
    mod = (_silu(c) @ w_mod).reshape(c.shape[0], 6, 1, -1)
    sa, ca, ga, sb, cb, gb = (mod[:, 0].clone(), mod[:, 1].clone(), mod[:, 2].clone(), mod[:, 3].clone(), mod[:, 4].clone(), mod[:, 5].clone())
    h = _layernorm(x, axis=-1) * (1 + ca) + sa
    x = x + ga * _A_ref(h, A_wqkv, A_wo)
    h = _layernorm(x, axis=-1) * (1 + cb) + sb
    x = x + gb * _B_ref(h, B_w_gate, B_w_up, B_w_down)
    return x
```

```asm
; @launch grid=(256,1,1) block=(256,1,1) lds=163840
.amdgcn_target "amdgcn-amd-amdhsa--gfx950"
.text
.globl adaLN_cond__sliding_block__glu_gated_glu__prompt_kernel
.p2align 8
.type adaLN_cond__sliding_block__glu_gated_glu__prompt_kernel,@function
adaLN_cond__sliding_block__glu_gated_glu__prompt_kernel:
    s_cmp_ge_u32 s2, 256
    s_cbranch_scc1 PK_END
    s_cmp_ge_u32 s2, 16
    s_cbranch_scc1 PK_FIRST
    s_getpc_b64 s[38:39]
    s_lshr_b32 s30, s2, 3
    s_lshl_b32 s30, s30, 15
    v_lshlrev_b32 v10, 7, v0
    v_add_u32 v10, s30, v10
    v_min_u32 v10, PK_LAST-PK_FIRST, v10
    v_mov_b32 v11, s39
    v_add_co_u32 v10, vcc, s38, v10
    v_addc_co_u32 v11, vcc, 0, v11, vcc
    global_load_dword v63, v[10:11], off
PK_FIRST:
    s_load_dwordx2 s[12:13], s[0:1], 88
    s_load_dwordx2 s[8:9], s[0:1], 0
    s_load_dwordx2 s[16:17], s[0:1], 56
    s_load_dwordx2 s[20:21], s[0:1], 64
    s_load_dwordx2 s[24:25], s[0:1], 8
    s_mov_b32 s14, 31719424
    s_mov_b32 s15, 0x00020000
    s_mov_b32 s10, 2097152
    s_mov_b32 s11, 0x00020000
    s_mov_b32 s18, 1024
    s_mov_b32 s19, 0x00020000
    s_mov_b32 s22, 3145728
    s_mov_b32 s23, 0x00020000
    s_mov_b32 s26, 1572864
    s_mov_b32 s27, 0x00020000
    v_and_b32 v1, 63, v0
    v_lshrrev_b32 v0, 6, v0
    s_nop 0
    v_readfirstlane_b32 s4, v0
    s_and_b32 s5, s2, 6
    s_lshl_b32 s5, s5, 2
    s_lshr_b32 s6, s2, 5
    s_add_u32 s5, s5, s6
    s_and_b32 s6, s2, 1
    s_lshl_b32 s6, s6, 2
    s_bfe_u32 s7, s2, 0x20003
    s_add_u32 s6, s6, s7
    s_lshl_b32 s7, s5, 3
    s_add_u32 s7, s7, s6
    v_lshlrev_b32 v2, 4, v1
    v_lshrrev_b32 v3, 3, v1
    v_and_b32 v4, 7, v1
    v_lshlrev_b32 v4, 4, v4
    s_movk_i32 s28, 6144
    v_mul_lo_u32 v5, v3, s28
    v_add_u32 v5, v5, v4
    v_lshlrev_b32 v6, 1, v3
    s_and_b32 s29, s2, 3
    s_lshl_b32 s29, s29, 2
    s_add_u32 s29, s29, s4
    s_lshl_b32 s30, s29, 6
    s_mul_i32 s29, s29, 196608
    s_lshr_b32 s31, s2, 2
    s_lshl_b32 s31, s31, 7
    s_add_u32 s29, s29, s31
    s_cmp_lt_u32 s2, 192
    s_cselect_b32 s29, s29, 0x7f000000
    s_lshl_b32 s32, s5, 16
    s_lshl_b32 s33, s4, 14
    s_add_u32 s32, s32, s33
    v_and_b32 v7, 16, v1
    v_lshlrev_b32 v7, 2, v7
    v_xor_b32 v7, v7, v4
    v_mul_u32_u24 v8, 3072, v3
    v_add_u32 v7, v7, v8
    s_mul_i32 s34, s4, 24576
    s_lshl_b32 s35, s6, 7
    s_add_u32 s34, s34, s35
    s_lshr_b32 s35, s4, 1
    s_mul_i32 s35, s35, 6144
    s_and_b32 s36, s4, 1
    s_lshl_b32 s36, s36, 10
    s_add_u32 s35, s35, s36
    s_add_u32 s35, s35, 65536
    s_waitcnt lgkmcnt(0)
    s_load_dwordx2 s[96:97], s[12:13], 622592
    buffer_load_ushort v12, v6, s[16:19], s30 offen offset:0
    buffer_load_ushort v13, v6, s[16:19], s30 offen offset:16
    buffer_load_ushort v14, v6, s[16:19], s30 offen offset:32
    buffer_load_ushort v15, v6, s[16:19], s30 offen offset:48
    buffer_load_dwordx4 v[16:19], v5, s[20:23], s29 offen
    s_add_u32 s29, s29, 49152
    buffer_load_dwordx4 v[20:23], v5, s[20:23], s29 offen
    s_add_u32 s29, s29, 49152
    buffer_load_dwordx4 v[24:27], v5, s[20:23], s29 offen
    s_add_u32 s29, s29, 49152
    buffer_load_dwordx4 v[28:31], v5, s[20:23], s29 offen
    s_add_u32 s29, s29, 49152
    buffer_load_dwordx4 v[192:195], v2, s[8:11], s32 offen offset:0
    buffer_load_dwordx4 v[196:199], v2, s[8:11], s32 offen offset:1024
    buffer_load_dwordx4 v[200:203], v2, s[8:11], s32 offen offset:2048
    buffer_load_dwordx4 v[204:207], v2, s[8:11], s32 offen offset:3072
    s_add_u32 s32, s32, 4096
    buffer_load_dwordx4 v[208:211], v2, s[8:11], s32 offen offset:0
    buffer_load_dwordx4 v[212:215], v2, s[8:11], s32 offen offset:1024
    buffer_load_dwordx4 v[216:219], v2, s[8:11], s32 offen offset:2048
    buffer_load_dwordx4 v[220:223], v2, s[8:11], s32 offen offset:3072
    s_add_u32 s32, s32, 4096
    buffer_load_dwordx4 v[224:227], v2, s[8:11], s32 offen offset:0
    buffer_load_dwordx4 v[228:231], v2, s[8:11], s32 offen offset:1024
    buffer_load_dwordx4 v[232:235], v2, s[8:11], s32 offen offset:2048
    buffer_load_dwordx4 v[236:239], v2, s[8:11], s32 offen offset:3072
    s_add_u32 s32, s32, 4096
    buffer_load_dwordx4 v[240:243], v2, s[8:11], s32 offen offset:0
    buffer_load_dwordx4 v[244:247], v2, s[8:11], s32 offen offset:1024
    buffer_load_dwordx4 v[248:251], v2, s[8:11], s32 offen offset:2048
    buffer_load_dwordx4 v[252:255], v2, s[8:11], s32 offen offset:3072
    s_add_u32 s32, s32, 4096
    v_mul_u32_u24 v10, 3072, v1
    s_and_b32 s45, s5, 7
    s_mul_i32 s45, s45, 196608
    s_lshl_b32 s33, s6, 7
    s_add_u32 s45, s45, s33
    s_min_u32 s33, s4, 2
    s_lshl_b32 s33, s33, 10
    s_add_u32 s45, s45, s33
    buffer_load_dword v62, v10, s[24:27], s45 offen
    s_waitcnt vmcnt(21)
    v_mov_b32 v32, 0
    v_mov_b32 v33, 0
    v_mov_b32 v34, 0
    v_mov_b32 v35, 0
    v_mov_b32 v36, 0
    v_mov_b32 v37, 0
    v_mov_b32 v38, 0
    v_mov_b32 v39, 0
    v_lshlrev_b32 v12, 16, v12
    v_mul_f32 v10, 3216550459, v12
    v_exp_f32 v10, v10
    s_nop 0
    v_add_f32 v10, 1.0, v10
    v_rcp_f32 v10, v10
    s_nop 0
    v_mul_f32 v12, v12, v10
    v_cvt_pk_bf16_f32 v12, v12, v12
    v_lshlrev_b32 v12, 16, v12
    v_lshlrev_b32 v13, 16, v13
    v_mul_f32 v10, 3216550459, v13
    v_exp_f32 v10, v10
    s_nop 0
    v_add_f32 v10, 1.0, v10
    v_rcp_f32 v10, v10
    s_nop 0
    v_mul_f32 v13, v13, v10
    v_cvt_pk_bf16_f32 v13, v13, v13
    v_lshlrev_b32 v13, 16, v13
    v_lshlrev_b32 v14, 16, v14
    v_mul_f32 v10, 3216550459, v14
    v_exp_f32 v10, v10
    s_nop 0
    v_add_f32 v10, 1.0, v10
    v_rcp_f32 v10, v10
    s_nop 0
    v_mul_f32 v14, v14, v10
    v_cvt_pk_bf16_f32 v14, v14, v14
    v_lshlrev_b32 v14, 16, v14
    v_lshlrev_b32 v15, 16, v15
    v_mul_f32 v10, 3216550459, v15
    v_exp_f32 v10, v10
    s_nop 0
    v_add_f32 v10, 1.0, v10
    v_rcp_f32 v10, v10
    s_nop 0
    v_mul_f32 v15, v15, v10
    v_cvt_pk_bf16_f32 v15, v15, v15
    v_lshlrev_b32 v15, 16, v15
    s_waitcnt vmcnt(20)
    v_lshlrev_b32 v10, 16, v16
    v_and_b32 v11, 0xffff0000, v16
    v_fmac_f32 v32, v10, v12
    v_fmac_f32 v33, v11, v12
    v_lshlrev_b32 v10, 16, v17
    v_and_b32 v11, 0xffff0000, v17
    v_fmac_f32 v34, v10, v12
    v_fmac_f32 v35, v11, v12
    v_lshlrev_b32 v10, 16, v18
    v_and_b32 v11, 0xffff0000, v18
    v_fmac_f32 v36, v10, v12
    v_fmac_f32 v37, v11, v12
    v_lshlrev_b32 v10, 16, v19
    v_and_b32 v11, 0xffff0000, v19
    v_fmac_f32 v38, v10, v12
    v_fmac_f32 v39, v11, v12
    s_waitcnt vmcnt(19)
    v_lshlrev_b32 v10, 16, v20
    v_and_b32 v11, 0xffff0000, v20
    v_fmac_f32 v32, v10, v13
    v_fmac_f32 v33, v11, v13
    v_lshlrev_b32 v10, 16, v21
    v_and_b32 v11, 0xffff0000, v21
    v_fmac_f32 v34, v10, v13
    v_fmac_f32 v35, v11, v13
    v_lshlrev_b32 v10, 16, v22
    v_and_b32 v11, 0xffff0000, v22
    v_fmac_f32 v36, v10, v13
    v_fmac_f32 v37, v11, v13
    v_lshlrev_b32 v10, 16, v23
    v_and_b32 v11, 0xffff0000, v23
    v_fmac_f32 v38, v10, v13
    v_fmac_f32 v39, v11, v13
    s_waitcnt vmcnt(18)
    v_lshlrev_b32 v10, 16, v24
    v_and_b32 v11, 0xffff0000, v24
    v_fmac_f32 v32, v10, v14
    v_fmac_f32 v33, v11, v14
    v_lshlrev_b32 v10, 16, v25
    v_and_b32 v11, 0xffff0000, v25
    v_fmac_f32 v34, v10, v14
    v_fmac_f32 v35, v11, v14
    v_lshlrev_b32 v10, 16, v26
    v_and_b32 v11, 0xffff0000, v26
    v_fmac_f32 v36, v10, v14
    v_fmac_f32 v37, v11, v14
    v_lshlrev_b32 v10, 16, v27
    v_and_b32 v11, 0xffff0000, v27
    v_fmac_f32 v38, v10, v14
    v_fmac_f32 v39, v11, v14
    s_waitcnt vmcnt(17)
    v_lshlrev_b32 v10, 16, v28
    v_and_b32 v11, 0xffff0000, v28
    v_fmac_f32 v32, v10, v15
    v_fmac_f32 v33, v11, v15
    v_lshlrev_b32 v10, 16, v29
    v_and_b32 v11, 0xffff0000, v29
    v_fmac_f32 v34, v10, v15
    v_fmac_f32 v35, v11, v15
    v_lshlrev_b32 v10, 16, v30
    v_and_b32 v11, 0xffff0000, v30
    v_fmac_f32 v36, v10, v15
    v_fmac_f32 v37, v11, v15
    v_lshlrev_b32 v10, 16, v31
    v_and_b32 v11, 0xffff0000, v31
    v_fmac_f32 v38, v10, v15
    v_fmac_f32 v39, v11, v15
    s_lshl_b32 s30, s4, 11
    v_lshlrev_b32 v10, 8, v3
    v_lshl_add_u32 v10, v4, 1, v10
    v_add_u32 v10, s30, v10
    ds_write_b128 v10, v[32:35]
    ds_write_b128 v10, v[36:39] offset:16
    s_waitcnt lgkmcnt(0)
    s_add_u32 s96, s96, 1
    s_addc_u32 s97, s97, 0
    s_barrier
    s_cmp_lg_u32 s4, 0
    s_cbranch_scc1 P0_A
    s_cmp_ge_u32 s2, 192
    s_cbranch_scc1 P0_A
    v_and_b32 v10, 31, v1
    v_lshrrev_b32 v11, 5, v1
    v_lshlrev_b32 v11, 12, v11
    v_lshl_add_u32 v11, v10, 3, v11
    v_lshlrev_b32 v10, 4, v10
    ds_read_b64 v[16:17], v11 offset:0
    ds_read_b64 v[18:19], v11 offset:256
    ds_read_b64 v[20:21], v11 offset:512
    ds_read_b64 v[22:23], v11 offset:768
    ds_read_b64 v[24:25], v11 offset:1024
    ds_read_b64 v[26:27], v11 offset:1280
    ds_read_b64 v[28:29], v11 offset:1536
    ds_read_b64 v[30:31], v11 offset:1792
    ds_read_b64 v[32:33], v11 offset:2048
    ds_read_b64 v[34:35], v11 offset:2304
    ds_read_b64 v[36:37], v11 offset:2560
    ds_read_b64 v[38:39], v11 offset:2816
    ds_read_b64 v[40:41], v11 offset:3072
    ds_read_b64 v[42:43], v11 offset:3328
    ds_read_b64 v[44:45], v11 offset:3584
    ds_read_b64 v[46:47], v11 offset:3840
    s_and_b32 s29, s2, 3
    s_mul_i32 s29, s29, 24576
    s_lshl_b32 s30, s31, 2
    s_add_u32 s29, s29, s30
    s_add_u32 s29, s29, 655360
    s_waitcnt lgkmcnt(0)
    v_add_f32 v16, v16, v32
    v_add_f32 v17, v17, v33
    v_add_f32 v18, v18, v34
    v_add_f32 v19, v19, v35
    v_add_f32 v20, v20, v36
    v_add_f32 v21, v21, v37
    v_add_f32 v22, v22, v38
    v_add_f32 v23, v23, v39
    v_add_f32 v24, v24, v40
    v_add_f32 v25, v25, v41
    v_add_f32 v26, v26, v42
    v_add_f32 v27, v27, v43
    v_add_f32 v28, v28, v44
    v_add_f32 v29, v29, v45
    v_add_f32 v30, v30, v46
    v_add_f32 v31, v31, v47
    v_add_f32 v16, v16, v24
    v_add_f32 v17, v17, v25
    v_add_f32 v18, v18, v26
    v_add_f32 v19, v19, v27
    v_add_f32 v20, v20, v28
    v_add_f32 v21, v21, v29
    v_add_f32 v22, v22, v30
    v_add_f32 v23, v23, v31
    v_add_f32 v16, v16, v20
    v_add_f32 v17, v17, v21
    v_add_f32 v18, v18, v22
    v_add_f32 v19, v19, v23
    v_add_f32 v16, v16, v18
    v_add_f32 v17, v17, v19
    v_mov_b32 v18, v16
    v_mov_b32 v19, v17
    s_nop 1
    v_permlane32_swap_b32 v16, v18
    v_permlane32_swap_b32 v17, v19
    v_add_f32 v56, v16, v18
    v_add_f32 v57, v17, v19
    v_mov_b32 v58, s96
    v_mov_b32 v59, s97
    buffer_store_dwordx4 v[56:59], v10, s[12:15], s29 offen sc1
P0_A:
    s_waitcnt vmcnt(16)
    v_lshlrev_b32 v64, 16, v192
    v_and_b32 v65, 0xffff0000, v192
    v_pk_mul_f32 v[50:51], v[64:65], v[64:65]
    v_lshlrev_b32 v66, 16, v193
    v_and_b32 v67, 0xffff0000, v193
    v_pk_add_f32 v[48:49], v[64:65], v[66:67]
    v_pk_fma_f32 v[50:51], v[66:67], v[66:67], v[50:51]
    v_lshlrev_b32 v68, 16, v194
    v_and_b32 v69, 0xffff0000, v194
    v_pk_add_f32 v[48:49], v[48:49], v[68:69]
    v_pk_fma_f32 v[50:51], v[68:69], v[68:69], v[50:51]
    v_lshlrev_b32 v70, 16, v195
    v_and_b32 v71, 0xffff0000, v195
    v_pk_add_f32 v[48:49], v[48:49], v[70:71]
    v_pk_fma_f32 v[50:51], v[70:71], v[70:71], v[50:51]
    v_add_f32 v16, v48, v49
    v_add_f32 v32, v50, v51
    s_waitcnt vmcnt(15)
    v_lshlrev_b32 v72, 16, v196
    v_and_b32 v73, 0xffff0000, v196
    v_pk_mul_f32 v[50:51], v[72:73], v[72:73]
    v_lshlrev_b32 v74, 16, v197
    v_and_b32 v75, 0xffff0000, v197
    v_pk_add_f32 v[48:49], v[72:73], v[74:75]
    v_pk_fma_f32 v[50:51], v[74:75], v[74:75], v[50:51]
    v_lshlrev_b32 v76, 16, v198
    v_and_b32 v77, 0xffff0000, v198
    v_pk_add_f32 v[48:49], v[48:49], v[76:77]
    v_pk_fma_f32 v[50:51], v[76:77], v[76:77], v[50:51]
    v_lshlrev_b32 v78, 16, v199
    v_and_b32 v79, 0xffff0000, v199
    v_pk_add_f32 v[48:49], v[48:49], v[78:79]
    v_pk_fma_f32 v[50:51], v[78:79], v[78:79], v[50:51]
    v_add_f32 v17, v48, v49
    v_add_f32 v33, v50, v51
    s_waitcnt vmcnt(14)
    v_lshlrev_b32 v80, 16, v200
    v_and_b32 v81, 0xffff0000, v200
    v_pk_mul_f32 v[50:51], v[80:81], v[80:81]
    v_lshlrev_b32 v82, 16, v201
    v_and_b32 v83, 0xffff0000, v201
    v_pk_add_f32 v[48:49], v[80:81], v[82:83]
    v_pk_fma_f32 v[50:51], v[82:83], v[82:83], v[50:51]
    v_lshlrev_b32 v84, 16, v202
    v_and_b32 v85, 0xffff0000, v202
    v_pk_add_f32 v[48:49], v[48:49], v[84:85]
    v_pk_fma_f32 v[50:51], v[84:85], v[84:85], v[50:51]
    v_lshlrev_b32 v86, 16, v203
    v_and_b32 v87, 0xffff0000, v203
    v_pk_add_f32 v[48:49], v[48:49], v[86:87]
    v_pk_fma_f32 v[50:51], v[86:87], v[86:87], v[50:51]
    v_add_f32 v18, v48, v49
    v_add_f32 v34, v50, v51
    s_waitcnt vmcnt(13)
    v_lshlrev_b32 v88, 16, v204
    v_and_b32 v89, 0xffff0000, v204
    v_pk_mul_f32 v[50:51], v[88:89], v[88:89]
    v_lshlrev_b32 v90, 16, v205
    v_and_b32 v91, 0xffff0000, v205
    v_pk_add_f32 v[48:49], v[88:89], v[90:91]
    v_pk_fma_f32 v[50:51], v[90:91], v[90:91], v[50:51]
    v_lshlrev_b32 v92, 16, v206
    v_and_b32 v93, 0xffff0000, v206
    v_pk_add_f32 v[48:49], v[48:49], v[92:93]
    v_pk_fma_f32 v[50:51], v[92:93], v[92:93], v[50:51]
    v_lshlrev_b32 v94, 16, v207
    v_and_b32 v95, 0xffff0000, v207
    v_pk_add_f32 v[48:49], v[48:49], v[94:95]
    v_pk_fma_f32 v[50:51], v[94:95], v[94:95], v[50:51]
    v_add_f32 v19, v48, v49
    v_add_f32 v35, v50, v51
    s_waitcnt vmcnt(12)
    v_lshlrev_b32 v96, 16, v208
    v_and_b32 v97, 0xffff0000, v208
    v_pk_mul_f32 v[50:51], v[96:97], v[96:97]
    v_lshlrev_b32 v98, 16, v209
    v_and_b32 v99, 0xffff0000, v209
    v_pk_add_f32 v[48:49], v[96:97], v[98:99]
    v_pk_fma_f32 v[50:51], v[98:99], v[98:99], v[50:51]
    v_lshlrev_b32 v100, 16, v210
    v_and_b32 v101, 0xffff0000, v210
    v_pk_add_f32 v[48:49], v[48:49], v[100:101]
    v_pk_fma_f32 v[50:51], v[100:101], v[100:101], v[50:51]
    v_lshlrev_b32 v102, 16, v211
    v_and_b32 v103, 0xffff0000, v211
    v_pk_add_f32 v[48:49], v[48:49], v[102:103]
    v_pk_fma_f32 v[50:51], v[102:103], v[102:103], v[50:51]
    v_add_f32 v20, v48, v49
    v_add_f32 v36, v50, v51
    s_waitcnt vmcnt(11)
    v_lshlrev_b32 v104, 16, v212
    v_and_b32 v105, 0xffff0000, v212
    v_pk_mul_f32 v[50:51], v[104:105], v[104:105]
    v_lshlrev_b32 v106, 16, v213
    v_and_b32 v107, 0xffff0000, v213
    v_pk_add_f32 v[48:49], v[104:105], v[106:107]
    v_pk_fma_f32 v[50:51], v[106:107], v[106:107], v[50:51]
    v_lshlrev_b32 v108, 16, v214
    v_and_b32 v109, 0xffff0000, v214
    v_pk_add_f32 v[48:49], v[48:49], v[108:109]
    v_pk_fma_f32 v[50:51], v[108:109], v[108:109], v[50:51]
    v_lshlrev_b32 v110, 16, v215
    v_and_b32 v111, 0xffff0000, v215
    v_pk_add_f32 v[48:49], v[48:49], v[110:111]
    v_pk_fma_f32 v[50:51], v[110:111], v[110:111], v[50:51]
    v_add_f32 v21, v48, v49
    v_add_f32 v37, v50, v51
    s_waitcnt vmcnt(10)
    v_lshlrev_b32 v112, 16, v216
    v_and_b32 v113, 0xffff0000, v216
    v_pk_mul_f32 v[50:51], v[112:113], v[112:113]
    v_lshlrev_b32 v114, 16, v217
    v_and_b32 v115, 0xffff0000, v217
    v_pk_add_f32 v[48:49], v[112:113], v[114:115]
    v_pk_fma_f32 v[50:51], v[114:115], v[114:115], v[50:51]
    v_lshlrev_b32 v116, 16, v218
    v_and_b32 v117, 0xffff0000, v218
    v_pk_add_f32 v[48:49], v[48:49], v[116:117]
    v_pk_fma_f32 v[50:51], v[116:117], v[116:117], v[50:51]
    v_lshlrev_b32 v118, 16, v219
    v_and_b32 v119, 0xffff0000, v219
    v_pk_add_f32 v[48:49], v[48:49], v[118:119]
    v_pk_fma_f32 v[50:51], v[118:119], v[118:119], v[50:51]
    v_add_f32 v22, v48, v49
    v_add_f32 v38, v50, v51
    s_waitcnt vmcnt(9)
    v_lshlrev_b32 v120, 16, v220
    v_and_b32 v121, 0xffff0000, v220
    v_pk_mul_f32 v[50:51], v[120:121], v[120:121]
    v_lshlrev_b32 v122, 16, v221
    v_and_b32 v123, 0xffff0000, v221
    v_pk_add_f32 v[48:49], v[120:121], v[122:123]
    v_pk_fma_f32 v[50:51], v[122:123], v[122:123], v[50:51]
    v_lshlrev_b32 v124, 16, v222
    v_and_b32 v125, 0xffff0000, v222
    v_pk_add_f32 v[48:49], v[48:49], v[124:125]
    v_pk_fma_f32 v[50:51], v[124:125], v[124:125], v[50:51]
    v_lshlrev_b32 v126, 16, v223
    v_and_b32 v127, 0xffff0000, v223
    v_pk_add_f32 v[48:49], v[48:49], v[126:127]
    v_pk_fma_f32 v[50:51], v[126:127], v[126:127], v[50:51]
    v_add_f32 v23, v48, v49
    v_add_f32 v39, v50, v51
    s_waitcnt vmcnt(8)
    v_lshlrev_b32 v128, 16, v224
    v_and_b32 v129, 0xffff0000, v224
    v_pk_mul_f32 v[50:51], v[128:129], v[128:129]
    v_lshlrev_b32 v130, 16, v225
    v_and_b32 v131, 0xffff0000, v225
    v_pk_add_f32 v[48:49], v[128:129], v[130:131]
    v_pk_fma_f32 v[50:51], v[130:131], v[130:131], v[50:51]
    v_lshlrev_b32 v132, 16, v226
    v_and_b32 v133, 0xffff0000, v226
    v_pk_add_f32 v[48:49], v[48:49], v[132:133]
    v_pk_fma_f32 v[50:51], v[132:133], v[132:133], v[50:51]
    v_lshlrev_b32 v134, 16, v227
    v_and_b32 v135, 0xffff0000, v227
    v_pk_add_f32 v[48:49], v[48:49], v[134:135]
    v_pk_fma_f32 v[50:51], v[134:135], v[134:135], v[50:51]
    v_add_f32 v24, v48, v49
    v_add_f32 v40, v50, v51
    s_waitcnt vmcnt(7)
    v_lshlrev_b32 v136, 16, v228
    v_and_b32 v137, 0xffff0000, v228
    v_pk_mul_f32 v[50:51], v[136:137], v[136:137]
    v_lshlrev_b32 v138, 16, v229
    v_and_b32 v139, 0xffff0000, v229
    v_pk_add_f32 v[48:49], v[136:137], v[138:139]
    v_pk_fma_f32 v[50:51], v[138:139], v[138:139], v[50:51]
    v_lshlrev_b32 v140, 16, v230
    v_and_b32 v141, 0xffff0000, v230
    v_pk_add_f32 v[48:49], v[48:49], v[140:141]
    v_pk_fma_f32 v[50:51], v[140:141], v[140:141], v[50:51]
    v_lshlrev_b32 v142, 16, v231
    v_and_b32 v143, 0xffff0000, v231
    v_pk_add_f32 v[48:49], v[48:49], v[142:143]
    v_pk_fma_f32 v[50:51], v[142:143], v[142:143], v[50:51]
    v_add_f32 v25, v48, v49
    v_add_f32 v41, v50, v51
    s_waitcnt vmcnt(6)
    v_lshlrev_b32 v144, 16, v232
    v_and_b32 v145, 0xffff0000, v232
    v_pk_mul_f32 v[50:51], v[144:145], v[144:145]
    v_lshlrev_b32 v146, 16, v233
    v_and_b32 v147, 0xffff0000, v233
    v_pk_add_f32 v[48:49], v[144:145], v[146:147]
    v_pk_fma_f32 v[50:51], v[146:147], v[146:147], v[50:51]
    v_lshlrev_b32 v148, 16, v234
    v_and_b32 v149, 0xffff0000, v234
    v_pk_add_f32 v[48:49], v[48:49], v[148:149]
    v_pk_fma_f32 v[50:51], v[148:149], v[148:149], v[50:51]
    v_lshlrev_b32 v150, 16, v235
    v_and_b32 v151, 0xffff0000, v235
    v_pk_add_f32 v[48:49], v[48:49], v[150:151]
    v_pk_fma_f32 v[50:51], v[150:151], v[150:151], v[50:51]
    v_add_f32 v26, v48, v49
    v_add_f32 v42, v50, v51
    s_waitcnt vmcnt(5)
    v_lshlrev_b32 v152, 16, v236
    v_and_b32 v153, 0xffff0000, v236
    v_pk_mul_f32 v[50:51], v[152:153], v[152:153]
    v_lshlrev_b32 v154, 16, v237
    v_and_b32 v155, 0xffff0000, v237
    v_pk_add_f32 v[48:49], v[152:153], v[154:155]
    v_pk_fma_f32 v[50:51], v[154:155], v[154:155], v[50:51]
    v_lshlrev_b32 v156, 16, v238
    v_and_b32 v157, 0xffff0000, v238
    v_pk_add_f32 v[48:49], v[48:49], v[156:157]
    v_pk_fma_f32 v[50:51], v[156:157], v[156:157], v[50:51]
    v_lshlrev_b32 v158, 16, v239
    v_and_b32 v159, 0xffff0000, v239
    v_pk_add_f32 v[48:49], v[48:49], v[158:159]
    v_pk_fma_f32 v[50:51], v[158:159], v[158:159], v[50:51]
    v_add_f32 v27, v48, v49
    v_add_f32 v43, v50, v51
    s_waitcnt vmcnt(4)
    v_lshlrev_b32 v160, 16, v240
    v_and_b32 v161, 0xffff0000, v240
    v_pk_mul_f32 v[50:51], v[160:161], v[160:161]
    v_lshlrev_b32 v162, 16, v241
    v_and_b32 v163, 0xffff0000, v241
    v_pk_add_f32 v[48:49], v[160:161], v[162:163]
    v_pk_fma_f32 v[50:51], v[162:163], v[162:163], v[50:51]
    v_lshlrev_b32 v164, 16, v242
    v_and_b32 v165, 0xffff0000, v242
    v_pk_add_f32 v[48:49], v[48:49], v[164:165]
    v_pk_fma_f32 v[50:51], v[164:165], v[164:165], v[50:51]
    v_lshlrev_b32 v166, 16, v243
    v_and_b32 v167, 0xffff0000, v243
    v_pk_add_f32 v[48:49], v[48:49], v[166:167]
    v_pk_fma_f32 v[50:51], v[166:167], v[166:167], v[50:51]
    v_add_f32 v28, v48, v49
    v_add_f32 v44, v50, v51
    s_waitcnt vmcnt(3)
    v_lshlrev_b32 v168, 16, v244
    v_and_b32 v169, 0xffff0000, v244
    v_pk_mul_f32 v[50:51], v[168:169], v[168:169]
    v_lshlrev_b32 v170, 16, v245
    v_and_b32 v171, 0xffff0000, v245
    v_pk_add_f32 v[48:49], v[168:169], v[170:171]
    v_pk_fma_f32 v[50:51], v[170:171], v[170:171], v[50:51]
    v_lshlrev_b32 v172, 16, v246
    v_and_b32 v173, 0xffff0000, v246
    v_pk_add_f32 v[48:49], v[48:49], v[172:173]
    v_pk_fma_f32 v[50:51], v[172:173], v[172:173], v[50:51]
    v_lshlrev_b32 v174, 16, v247
    v_and_b32 v175, 0xffff0000, v247
    v_pk_add_f32 v[48:49], v[48:49], v[174:175]
    v_pk_fma_f32 v[50:51], v[174:175], v[174:175], v[50:51]
    v_add_f32 v29, v48, v49
    v_add_f32 v45, v50, v51
    s_waitcnt vmcnt(2)
    v_lshlrev_b32 v176, 16, v248
    v_and_b32 v177, 0xffff0000, v248
    v_pk_mul_f32 v[50:51], v[176:177], v[176:177]
    v_lshlrev_b32 v178, 16, v249
    v_and_b32 v179, 0xffff0000, v249
    v_pk_add_f32 v[48:49], v[176:177], v[178:179]
    v_pk_fma_f32 v[50:51], v[178:179], v[178:179], v[50:51]
    v_lshlrev_b32 v180, 16, v250
    v_and_b32 v181, 0xffff0000, v250
    v_pk_add_f32 v[48:49], v[48:49], v[180:181]
    v_pk_fma_f32 v[50:51], v[180:181], v[180:181], v[50:51]
    v_lshlrev_b32 v182, 16, v251
    v_and_b32 v183, 0xffff0000, v251
    v_pk_add_f32 v[48:49], v[48:49], v[182:183]
    v_pk_fma_f32 v[50:51], v[182:183], v[182:183], v[50:51]
    v_add_f32 v30, v48, v49
    v_add_f32 v46, v50, v51
    s_waitcnt vmcnt(1)
    v_lshlrev_b32 v184, 16, v252
    v_and_b32 v185, 0xffff0000, v252
    v_pk_mul_f32 v[50:51], v[184:185], v[184:185]
    v_lshlrev_b32 v186, 16, v253
    v_and_b32 v187, 0xffff0000, v253
    v_pk_add_f32 v[48:49], v[184:185], v[186:187]
    v_pk_fma_f32 v[50:51], v[186:187], v[186:187], v[50:51]
    v_lshlrev_b32 v188, 16, v254
    v_and_b32 v189, 0xffff0000, v254
    v_pk_add_f32 v[48:49], v[48:49], v[188:189]
    v_pk_fma_f32 v[50:51], v[188:189], v[188:189], v[50:51]
    v_lshlrev_b32 v190, 16, v255
    v_and_b32 v191, 0xffff0000, v255
    v_pk_add_f32 v[48:49], v[48:49], v[190:191]
    v_pk_fma_f32 v[50:51], v[190:191], v[190:191], v[50:51]
    v_add_f32 v31, v48, v49
    v_add_f32 v47, v50, v51
    s_nop 1
    v_permlane32_swap_b32 v16, v24
    v_permlane32_swap_b32 v17, v25
    v_permlane32_swap_b32 v18, v26
    v_permlane32_swap_b32 v19, v27
    v_permlane32_swap_b32 v20, v28
    v_permlane32_swap_b32 v21, v29
    v_permlane32_swap_b32 v22, v30
    v_permlane32_swap_b32 v23, v31
    v_add_f32 v16, v16, v24
    v_add_f32 v17, v17, v25
    v_add_f32 v18, v18, v26
    v_add_f32 v19, v19, v27
    v_add_f32 v20, v20, v28
    v_add_f32 v21, v21, v29
    v_add_f32 v22, v22, v30
    v_add_f32 v23, v23, v31
    v_permlane32_swap_b32 v32, v40
    v_permlane32_swap_b32 v33, v41
    v_permlane32_swap_b32 v34, v42
    v_permlane32_swap_b32 v35, v43
    v_permlane32_swap_b32 v36, v44
    v_permlane32_swap_b32 v37, v45
    v_permlane32_swap_b32 v38, v46
    v_permlane32_swap_b32 v39, v47
    v_add_f32 v32, v32, v40
    v_add_f32 v33, v33, v41
    v_add_f32 v34, v34, v42
    v_add_f32 v35, v35, v43
    v_add_f32 v36, v36, v44
    v_add_f32 v37, v37, v45
    v_add_f32 v38, v38, v46
    v_add_f32 v39, v39, v47
    v_permlane16_swap_b32 v16, v20
    v_permlane16_swap_b32 v17, v21
    v_permlane16_swap_b32 v18, v22
    v_permlane16_swap_b32 v19, v23
    v_permlane16_swap_b32 v32, v36
    v_permlane16_swap_b32 v33, v37
    v_permlane16_swap_b32 v34, v38
    v_permlane16_swap_b32 v35, v39
    v_add_f32 v16, v16, v20
    v_add_f32 v17, v17, v21
    v_add_f32 v18, v18, v22
    v_add_f32 v19, v19, v23
    v_add_f32 v32, v32, v36
    v_add_f32 v33, v33, v37
    v_add_f32 v34, v34, v38
    v_add_f32 v35, v35, v39
    v_add_f32_dpp v16, v16, v16 row_ror:8 row_mask:0xf bank_mask:0xf
    v_add_f32_dpp v17, v17, v17 row_ror:8 row_mask:0xf bank_mask:0xf
    v_add_f32_dpp v18, v18, v18 row_ror:8 row_mask:0xf bank_mask:0xf
    v_add_f32_dpp v19, v19, v19 row_ror:8 row_mask:0xf bank_mask:0xf
    v_add_f32_dpp v32, v32, v32 row_ror:8 row_mask:0xf bank_mask:0xf
    v_add_f32_dpp v33, v33, v33 row_ror:8 row_mask:0xf bank_mask:0xf
    v_add_f32_dpp v34, v34, v34 row_ror:8 row_mask:0xf bank_mask:0xf
    v_add_f32_dpp v35, v35, v35 row_ror:8 row_mask:0xf bank_mask:0xf
    v_add_f32_dpp v16, v16, v16 row_ror:4 row_mask:0xf bank_mask:0xf
    v_add_f32_dpp v17, v17, v17 row_ror:4 row_mask:0xf bank_mask:0xf
    v_add_f32_dpp v18, v18, v18 row_ror:4 row_mask:0xf bank_mask:0xf
    v_add_f32_dpp v19, v19, v19 row_ror:4 row_mask:0xf bank_mask:0xf
    v_add_f32_dpp v32, v32, v32 row_ror:4 row_mask:0xf bank_mask:0xf
    v_add_f32_dpp v33, v33, v33 row_ror:4 row_mask:0xf bank_mask:0xf
    v_add_f32_dpp v34, v34, v34 row_ror:4 row_mask:0xf bank_mask:0xf
    v_add_f32_dpp v35, v35, v35 row_ror:4 row_mask:0xf bank_mask:0xf
    v_add_f32_dpp v16, v16, v16 row_ror:2 row_mask:0xf bank_mask:0xf
    v_add_f32_dpp v17, v17, v17 row_ror:2 row_mask:0xf bank_mask:0xf
    v_add_f32_dpp v18, v18, v18 row_ror:2 row_mask:0xf bank_mask:0xf
    v_add_f32_dpp v19, v19, v19 row_ror:2 row_mask:0xf bank_mask:0xf
    v_add_f32_dpp v32, v32, v32 row_ror:2 row_mask:0xf bank_mask:0xf
    v_add_f32_dpp v33, v33, v33 row_ror:2 row_mask:0xf bank_mask:0xf
    v_add_f32_dpp v34, v34, v34 row_ror:2 row_mask:0xf bank_mask:0xf
    v_add_f32_dpp v35, v35, v35 row_ror:2 row_mask:0xf bank_mask:0xf
    v_add_f32_dpp v16, v16, v16 row_ror:1 row_mask:0xf bank_mask:0xf
    v_add_f32_dpp v17, v17, v17 row_ror:1 row_mask:0xf bank_mask:0xf
    v_add_f32_dpp v18, v18, v18 row_ror:1 row_mask:0xf bank_mask:0xf
    v_add_f32_dpp v19, v19, v19 row_ror:1 row_mask:0xf bank_mask:0xf
    v_add_f32_dpp v32, v32, v32 row_ror:1 row_mask:0xf bank_mask:0xf
    v_add_f32_dpp v33, v33, v33 row_ror:1 row_mask:0xf bank_mask:0xf
    v_add_f32_dpp v34, v34, v34 row_ror:1 row_mask:0xf bank_mask:0xf
    v_add_f32_dpp v35, v35, v35 row_ror:1 row_mask:0xf bank_mask:0xf
    v_mul_f32 v16, 989855744, v16
    v_mul_f32 v32, 989855744, v32
    v_fma_f32 v32, -v16, v16, v32
    v_max_f32 v32, 0, v32
    v_add_f32 v32, 925353388, v32
    v_rsq_f32 v32, v32
    s_nop 0
    v_mul_f32 v16, v16, v32
    v_mul_f32 v17, 989855744, v17
    v_mul_f32 v33, 989855744, v33
    v_fma_f32 v33, -v17, v17, v33
    v_max_f32 v33, 0, v33
    v_add_f32 v33, 925353388, v33
    v_rsq_f32 v33, v33
    s_nop 0
    v_mul_f32 v17, v17, v33
    v_mul_f32 v18, 989855744, v18
    v_mul_f32 v34, 989855744, v34
    v_fma_f32 v34, -v18, v18, v34
    v_max_f32 v34, 0, v34
    v_add_f32 v34, 925353388, v34
    v_rsq_f32 v34, v34
    s_nop 0
    v_mul_f32 v18, v18, v34
    v_mul_f32 v19, 989855744, v19
    v_mul_f32 v35, 989855744, v35
    v_fma_f32 v35, -v19, v19, v35
    v_max_f32 v35, 0, v35
    v_add_f32 v35, 925353388, v35
    v_rsq_f32 v35, v35
    s_nop 0
    v_mul_f32 v19, v19, v35
    s_nop 1
    v_readlane_b32 s41, v16, 0
    v_readlane_b32 s40, v32, 0
    s_nop 0
    v_mov_b32 v48, s41
    v_pk_fma_f32 v[64:65], v[64:65], s[40:41], v[48:49] op_sel_hi:[1,0,0] neg_lo:[0,0,1] neg_hi:[0,0,1]
    v_pk_fma_f32 v[66:67], v[66:67], s[40:41], v[48:49] op_sel_hi:[1,0,0] neg_lo:[0,0,1] neg_hi:[0,0,1]
    v_pk_fma_f32 v[68:69], v[68:69], s[40:41], v[48:49] op_sel_hi:[1,0,0] neg_lo:[0,0,1] neg_hi:[0,0,1]
    v_pk_fma_f32 v[70:71], v[70:71], s[40:41], v[48:49] op_sel_hi:[1,0,0] neg_lo:[0,0,1] neg_hi:[0,0,1]
    v_readlane_b32 s43, v17, 0
    v_readlane_b32 s42, v33, 0
    s_nop 0
    v_mov_b32 v48, s43
    v_pk_fma_f32 v[72:73], v[72:73], s[42:43], v[48:49] op_sel_hi:[1,0,0] neg_lo:[0,0,1] neg_hi:[0,0,1]
    v_pk_fma_f32 v[74:75], v[74:75], s[42:43], v[48:49] op_sel_hi:[1,0,0] neg_lo:[0,0,1] neg_hi:[0,0,1]
    v_pk_fma_f32 v[76:77], v[76:77], s[42:43], v[48:49] op_sel_hi:[1,0,0] neg_lo:[0,0,1] neg_hi:[0,0,1]
    v_pk_fma_f32 v[78:79], v[78:79], s[42:43], v[48:49] op_sel_hi:[1,0,0] neg_lo:[0,0,1] neg_hi:[0,0,1]
    v_readlane_b32 s41, v18, 0
    v_readlane_b32 s40, v34, 0
    s_nop 0
    v_mov_b32 v48, s41
    v_pk_fma_f32 v[80:81], v[80:81], s[40:41], v[48:49] op_sel_hi:[1,0,0] neg_lo:[0,0,1] neg_hi:[0,0,1]
    v_pk_fma_f32 v[82:83], v[82:83], s[40:41], v[48:49] op_sel_hi:[1,0,0] neg_lo:[0,0,1] neg_hi:[0,0,1]
    v_pk_fma_f32 v[84:85], v[84:85], s[40:41], v[48:49] op_sel_hi:[1,0,0] neg_lo:[0,0,1] neg_hi:[0,0,1]
    v_pk_fma_f32 v[86:87], v[86:87], s[40:41], v[48:49] op_sel_hi:[1,0,0] neg_lo:[0,0,1] neg_hi:[0,0,1]
    v_readlane_b32 s43, v19, 0
    v_readlane_b32 s42, v35, 0
    s_nop 0
    v_mov_b32 v48, s43
    v_pk_fma_f32 v[88:89], v[88:89], s[42:43], v[48:49] op_sel_hi:[1,0,0] neg_lo:[0,0,1] neg_hi:[0,0,1]
    v_pk_fma_f32 v[90:91], v[90:91], s[42:43], v[48:49] op_sel_hi:[1,0,0] neg_lo:[0,0,1] neg_hi:[0,0,1]
    v_pk_fma_f32 v[92:93], v[92:93], s[42:43], v[48:49] op_sel_hi:[1,0,0] neg_lo:[0,0,1] neg_hi:[0,0,1]
    v_pk_fma_f32 v[94:95], v[94:95], s[42:43], v[48:49] op_sel_hi:[1,0,0] neg_lo:[0,0,1] neg_hi:[0,0,1]
    v_readlane_b32 s41, v16, 16
    v_readlane_b32 s40, v32, 16
    s_nop 0
    v_mov_b32 v48, s41
    v_pk_fma_f32 v[96:97], v[96:97], s[40:41], v[48:49] op_sel_hi:[1,0,0] neg_lo:[0,0,1] neg_hi:[0,0,1]
    v_pk_fma_f32 v[98:99], v[98:99], s[40:41], v[48:49] op_sel_hi:[1,0,0] neg_lo:[0,0,1] neg_hi:[0,0,1]
    v_pk_fma_f32 v[100:101], v[100:101], s[40:41], v[48:49] op_sel_hi:[1,0,0] neg_lo:[0,0,1] neg_hi:[0,0,1]
    v_pk_fma_f32 v[102:103], v[102:103], s[40:41], v[48:49] op_sel_hi:[1,0,0] neg_lo:[0,0,1] neg_hi:[0,0,1]
    v_readlane_b32 s43, v17, 16
    v_readlane_b32 s42, v33, 16
    s_nop 0
    v_mov_b32 v48, s43
    v_pk_fma_f32 v[104:105], v[104:105], s[42:43], v[48:49] op_sel_hi:[1,0,0] neg_lo:[0,0,1] neg_hi:[0,0,1]
    v_pk_fma_f32 v[106:107], v[106:107], s[42:43], v[48:49] op_sel_hi:[1,0,0] neg_lo:[0,0,1] neg_hi:[0,0,1]
    v_pk_fma_f32 v[108:109], v[108:109], s[42:43], v[48:49] op_sel_hi:[1,0,0] neg_lo:[0,0,1] neg_hi:[0,0,1]
    v_pk_fma_f32 v[110:111], v[110:111], s[42:43], v[48:49] op_sel_hi:[1,0,0] neg_lo:[0,0,1] neg_hi:[0,0,1]
    v_readlane_b32 s41, v18, 16
    v_readlane_b32 s40, v34, 16
    s_nop 0
    v_mov_b32 v48, s41
    v_pk_fma_f32 v[112:113], v[112:113], s[40:41], v[48:49] op_sel_hi:[1,0,0] neg_lo:[0,0,1] neg_hi:[0,0,1]
    v_pk_fma_f32 v[114:115], v[114:115], s[40:41], v[48:49] op_sel_hi:[1,0,0] neg_lo:[0,0,1] neg_hi:[0,0,1]
    v_pk_fma_f32 v[116:117], v[116:117], s[40:41], v[48:49] op_sel_hi:[1,0,0] neg_lo:[0,0,1] neg_hi:[0,0,1]
    v_pk_fma_f32 v[118:119], v[118:119], s[40:41], v[48:49] op_sel_hi:[1,0,0] neg_lo:[0,0,1] neg_hi:[0,0,1]
    v_readlane_b32 s43, v19, 16
    v_readlane_b32 s42, v35, 16
    s_nop 0
    v_mov_b32 v48, s43
    v_pk_fma_f32 v[120:121], v[120:121], s[42:43], v[48:49] op_sel_hi:[1,0,0] neg_lo:[0,0,1] neg_hi:[0,0,1]
    v_pk_fma_f32 v[122:123], v[122:123], s[42:43], v[48:49] op_sel_hi:[1,0,0] neg_lo:[0,0,1] neg_hi:[0,0,1]
    v_pk_fma_f32 v[124:125], v[124:125], s[42:43], v[48:49] op_sel_hi:[1,0,0] neg_lo:[0,0,1] neg_hi:[0,0,1]
    v_pk_fma_f32 v[126:127], v[126:127], s[42:43], v[48:49] op_sel_hi:[1,0,0] neg_lo:[0,0,1] neg_hi:[0,0,1]
    v_readlane_b32 s41, v16, 32
    v_readlane_b32 s40, v32, 32
    s_nop 0
    v_mov_b32 v48, s41
    v_pk_fma_f32 v[128:129], v[128:129], s[40:41], v[48:49] op_sel_hi:[1,0,0] neg_lo:[0,0,1] neg_hi:[0,0,1]
    v_pk_fma_f32 v[130:131], v[130:131], s[40:41], v[48:49] op_sel_hi:[1,0,0] neg_lo:[0,0,1] neg_hi:[0,0,1]
    v_pk_fma_f32 v[132:133], v[132:133], s[40:41], v[48:49] op_sel_hi:[1,0,0] neg_lo:[0,0,1] neg_hi:[0,0,1]
    v_pk_fma_f32 v[134:135], v[134:135], s[40:41], v[48:49] op_sel_hi:[1,0,0] neg_lo:[0,0,1] neg_hi:[0,0,1]
    v_readlane_b32 s43, v17, 32
    v_readlane_b32 s42, v33, 32
    s_nop 0
    v_mov_b32 v48, s43
    v_pk_fma_f32 v[136:137], v[136:137], s[42:43], v[48:49] op_sel_hi:[1,0,0] neg_lo:[0,0,1] neg_hi:[0,0,1]
    v_pk_fma_f32 v[138:139], v[138:139], s[42:43], v[48:49] op_sel_hi:[1,0,0] neg_lo:[0,0,1] neg_hi:[0,0,1]
    v_pk_fma_f32 v[140:141], v[140:141], s[42:43], v[48:49] op_sel_hi:[1,0,0] neg_lo:[0,0,1] neg_hi:[0,0,1]
    v_pk_fma_f32 v[142:143], v[142:143], s[42:43], v[48:49] op_sel_hi:[1,0,0] neg_lo:[0,0,1] neg_hi:[0,0,1]
    v_readlane_b32 s41, v18, 32
    v_readlane_b32 s40, v34, 32
    s_nop 0
    v_mov_b32 v48, s41
    v_pk_fma_f32 v[144:145], v[144:145], s[40:41], v[48:49] op_sel_hi:[1,0,0] neg_lo:[0,0,1] neg_hi:[0,0,1]
    v_pk_fma_f32 v[146:147], v[146:147], s[40:41], v[48:49] op_sel_hi:[1,0,0] neg_lo:[0,0,1] neg_hi:[0,0,1]
    v_pk_fma_f32 v[148:149], v[148:149], s[40:41], v[48:49] op_sel_hi:[1,0,0] neg_lo:[0,0,1] neg_hi:[0,0,1]
    v_pk_fma_f32 v[150:151], v[150:151], s[40:41], v[48:49] op_sel_hi:[1,0,0] neg_lo:[0,0,1] neg_hi:[0,0,1]
    v_readlane_b32 s43, v19, 32
    v_readlane_b32 s42, v35, 32
    s_nop 0
    v_mov_b32 v48, s43
    v_pk_fma_f32 v[152:153], v[152:153], s[42:43], v[48:49] op_sel_hi:[1,0,0] neg_lo:[0,0,1] neg_hi:[0,0,1]
    v_pk_fma_f32 v[154:155], v[154:155], s[42:43], v[48:49] op_sel_hi:[1,0,0] neg_lo:[0,0,1] neg_hi:[0,0,1]
    v_pk_fma_f32 v[156:157], v[156:157], s[42:43], v[48:49] op_sel_hi:[1,0,0] neg_lo:[0,0,1] neg_hi:[0,0,1]
    v_pk_fma_f32 v[158:159], v[158:159], s[42:43], v[48:49] op_sel_hi:[1,0,0] neg_lo:[0,0,1] neg_hi:[0,0,1]
    v_readlane_b32 s41, v16, 48
    v_readlane_b32 s40, v32, 48
    s_nop 0
    v_mov_b32 v48, s41
    v_pk_fma_f32 v[160:161], v[160:161], s[40:41], v[48:49] op_sel_hi:[1,0,0] neg_lo:[0,0,1] neg_hi:[0,0,1]
    v_pk_fma_f32 v[162:163], v[162:163], s[40:41], v[48:49] op_sel_hi:[1,0,0] neg_lo:[0,0,1] neg_hi:[0,0,1]
    v_pk_fma_f32 v[164:165], v[164:165], s[40:41], v[48:49] op_sel_hi:[1,0,0] neg_lo:[0,0,1] neg_hi:[0,0,1]
    v_pk_fma_f32 v[166:167], v[166:167], s[40:41], v[48:49] op_sel_hi:[1,0,0] neg_lo:[0,0,1] neg_hi:[0,0,1]
    v_readlane_b32 s43, v17, 48
    v_readlane_b32 s42, v33, 48
    s_nop 0
    v_mov_b32 v48, s43
    v_pk_fma_f32 v[168:169], v[168:169], s[42:43], v[48:49] op_sel_hi:[1,0,0] neg_lo:[0,0,1] neg_hi:[0,0,1]
    v_pk_fma_f32 v[170:171], v[170:171], s[42:43], v[48:49] op_sel_hi:[1,0,0] neg_lo:[0,0,1] neg_hi:[0,0,1]
    v_pk_fma_f32 v[172:173], v[172:173], s[42:43], v[48:49] op_sel_hi:[1,0,0] neg_lo:[0,0,1] neg_hi:[0,0,1]
    v_pk_fma_f32 v[174:175], v[174:175], s[42:43], v[48:49] op_sel_hi:[1,0,0] neg_lo:[0,0,1] neg_hi:[0,0,1]
    v_readlane_b32 s41, v18, 48
    v_readlane_b32 s40, v34, 48
    s_nop 0
    v_mov_b32 v48, s41
    v_pk_fma_f32 v[176:177], v[176:177], s[40:41], v[48:49] op_sel_hi:[1,0,0] neg_lo:[0,0,1] neg_hi:[0,0,1]
    v_pk_fma_f32 v[178:179], v[178:179], s[40:41], v[48:49] op_sel_hi:[1,0,0] neg_lo:[0,0,1] neg_hi:[0,0,1]
    v_pk_fma_f32 v[180:181], v[180:181], s[40:41], v[48:49] op_sel_hi:[1,0,0] neg_lo:[0,0,1] neg_hi:[0,0,1]
    v_pk_fma_f32 v[182:183], v[182:183], s[40:41], v[48:49] op_sel_hi:[1,0,0] neg_lo:[0,0,1] neg_hi:[0,0,1]
    v_readlane_b32 s43, v19, 48
    v_readlane_b32 s42, v35, 48
    s_nop 0
    v_mov_b32 v48, s43
    v_pk_fma_f32 v[184:185], v[184:185], s[42:43], v[48:49] op_sel_hi:[1,0,0] neg_lo:[0,0,1] neg_hi:[0,0,1]
    v_pk_fma_f32 v[186:187], v[186:187], s[42:43], v[48:49] op_sel_hi:[1,0,0] neg_lo:[0,0,1] neg_hi:[0,0,1]
    v_pk_fma_f32 v[188:189], v[188:189], s[42:43], v[48:49] op_sel_hi:[1,0,0] neg_lo:[0,0,1] neg_hi:[0,0,1]
    v_pk_fma_f32 v[190:191], v[190:191], s[42:43], v[48:49] op_sel_hi:[1,0,0] neg_lo:[0,0,1] neg_hi:[0,0,1]
    v_and_b32 v10, 7, v1
    s_and_b32 s30, s4, 1
    s_lshl_b32 s30, s30, 8
    s_lshr_b32 s31, s4, 1
    s_lshl_b32 s31, s31, 15
    s_add_u32 s30, s30, s31
    v_lshlrev_b32 v10, 4, v10
    v_lshl_add_u32 v10, v1, 9, v10
    v_add_u32 v10, s30, v10
    v_lshrrev_b32 v11, 5, v1
    v_and_b32 v12, 31, v1
    v_xor_b32 v12, v12, v11
    v_lshlrev_b32 v12, 4, v12
    v_lshl_add_u32 v12, v11, 9, v12
    v_add_u32 v12, s31, v12
    v_xor_b32 v13, 32, v12
    v_xor_b32 v14, 64, v12
    v_xor_b32 v15, 96, v12
    v_bfe_u32 v8, v1, 2, 2
    v_lshl_add_u32 v8, v11, 3, v8
    v_lshlrev_b32 v8, 7, v8
    v_and_b32 v9, 3, v1
    v_lshl_add_u32 v8, v9, 3, v8
    v_bfe_u32 v9, v1, 4, 1
    v_lshl_add_u32 v8, v9, 5, v8
    v_bfe_u32 v9, v1, 3, 1
    s_and_b32 s30, s4, 1
    v_xor_b32 v9, s30, v9
    v_lshl_add_u32 v8, v9, 6, v8
    v_add_u32 v8, 65536, v8
    v_add_u32 v9, 36864, v8
    s_lshl_b32 s30, s4, 10
    v_add_u32 v6, s30, v2
    v_lshlrev_b32 v5, 5, v1
    v_add_u32 v5, 155648, v5
    s_add_u32 m0, s35, 0
    s_add_u32 s37, s34, 0
    buffer_load_dwordx4 v7, s[24:27], s37 offen lds
    s_add_u32 m0, s35, 2048
    s_add_u32 s37, s34, 1024
    buffer_load_dwordx4 v7, s[24:27], s37 offen lds
    s_add_u32 m0, s35, 4096
    s_add_u32 s37, s34, 2048
    buffer_load_dwordx4 v7, s[24:27], s37 offen lds
    s_add_u32 s34, s34, 98304
    s_add_u32 m0, s35, 12288
    s_add_u32 s37, s34, 0
    buffer_load_dwordx4 v7, s[24:27], s37 offen lds
    s_add_u32 m0, s35, 14336
    s_add_u32 s37, s34, 1024
    buffer_load_dwordx4 v7, s[24:27], s37 offen lds
    s_add_u32 m0, s35, 16384
    s_add_u32 s37, s34, 2048
    buffer_load_dwordx4 v7, s[24:27], s37 offen lds
    s_add_u32 s34, s34, 98304
    s_add_u32 m0, s35, 24576
    s_add_u32 s37, s34, 0
    buffer_load_dwordx4 v7, s[24:27], s37 offen lds
    s_add_u32 m0, s35, 26624
    s_add_u32 s37, s34, 1024
    buffer_load_dwordx4 v7, s[24:27], s37 offen lds
    s_add_u32 m0, s35, 28672
    s_add_u32 s37, s34, 2048
    buffer_load_dwordx4 v7, s[24:27], s37 offen lds
    s_add_u32 s34, s34, 98304
    s_add_u32 m0, s35, 36864
    s_add_u32 s37, s34, 0
    buffer_load_dwordx4 v7, s[24:27], s37 offen lds
    s_add_u32 m0, s35, 38912
    s_add_u32 s37, s34, 1024
    buffer_load_dwordx4 v7, s[24:27], s37 offen lds
    s_add_u32 m0, s35, 40960
    s_add_u32 s37, s34, 2048
    buffer_load_dwordx4 v7, s[24:27], s37 offen lds
    s_add_u32 s34, s34, 98304
    s_add_u32 m0, s35, 49152
    s_add_u32 s37, s34, 0
    buffer_load_dwordx4 v7, s[24:27], s37 offen lds
    s_add_u32 m0, s35, 51200
    s_add_u32 s37, s34, 1024
    buffer_load_dwordx4 v7, s[24:27], s37 offen lds
    s_add_u32 m0, s35, 53248
    s_add_u32 s37, s34, 2048
    buffer_load_dwordx4 v7, s[24:27], s37 offen lds
    s_add_u32 s34, s34, 98304
    s_add_u32 m0, s35, 61440
    s_add_u32 s37, s34, 0
    buffer_load_dwordx4 v7, s[24:27], s37 offen lds
    s_add_u32 m0, s35, 63488
    s_add_u32 s37, s34, 1024
    buffer_load_dwordx4 v7, s[24:27], s37 offen lds
    s_add_u32 m0, s35, 65536
    s_add_u32 s37, s34, 2048
    buffer_load_dwordx4 v7, s[24:27], s37 offen lds
    s_add_u32 s34, s34, 98304
    s_cmp_lt_u32 s2, 224
    s_cbranch_scc1 MF9
    s_cmp_lg_u32 s4, 0
    s_cbranch_scc1 MF9
    s_sub_u32 s30, s2, 208
    v_and_b32 v36, 31, v1
    v_lshlrev_b32 v36, 4, v36
    s_lshl_b32 s31, s30, 9
    v_add_u32 v36, s31, v36
    s_mov_b32 s99, 0
PL1:
    s_mov_b32 s98, 655360
    buffer_load_dwordx4 v[40:43], v36, s[12:15], s98 offen sc1
    s_mov_b32 s98, 679936
    buffer_load_dwordx4 v[44:47], v36, s[12:15], s98 offen sc1
    s_mov_b32 s98, 704512
    buffer_load_dwordx4 v[48:51], v36, s[12:15], s98 offen sc1
    s_mov_b32 s98, 729088
    buffer_load_dwordx4 v[52:55], v36, s[12:15], s98 offen sc1
    s_add_u32 s99, s99, 1
    s_waitcnt vmcnt(0)
    v_cmp_ne_u64 vcc, s[96:97], v[42:43]
    v_cmp_ne_u64 s[100:101], s[96:97], v[46:47]
    s_or_b64 vcc, vcc, s[100:101]
    v_cmp_ne_u64 s[100:101], s[96:97], v[50:51]
    s_or_b64 vcc, vcc, s[100:101]
    v_cmp_ne_u64 s[100:101], s[96:97], v[54:55]
    s_or_b64 vcc, vcc, s[100:101]
    s_cmp_eq_u64 vcc, 0
    s_cbranch_scc1 PD1
    s_sleep 4
    s_cmp_lt_u32 s99, 50000
    s_cbranch_scc1 PL1
PD1:
    s_lshr_b32 s30, s30, 3
    s_cmp_eq_u32 s30, 4
    s_cselect_b32 s30, 1.0, 0
    v_lshrrev_b32 v36, 1, v36
    v_add_f32 v40, v40, v44
    v_add_f32 v48, v48, v52
    v_add_f32 v38, v40, v48
    v_add_f32 v41, v41, v45
    v_add_f32 v49, v49, v53
    v_add_f32 v39, v41, v49
    v_cvt_pk_bf16_f32 v37, v38, v39
    v_lshlrev_b32 v38, 16, v37
    v_and_b32 v39, 0xffff0000, v37
    v_add_f32 v38, s30, v38
    v_add_f32 v39, s30, v39
    v_cvt_pk_bf16_f32 v37, v38, v39
    v_lshlrev_b32 v38, 16, v37
    v_and_b32 v39, 0xffff0000, v37
    buffer_store_dwordx2 v[38:39], v36, s[12:15], 0 offen sc1
MF9:
    s_mov_b32 s99, 0
PL2:
    s_mov_b32 s98, 655360
    buffer_load_dwordx4 v[192:195], v6, s[12:15], s98 offen sc1
    s_mov_b32 s98, 679936
    buffer_load_dwordx4 v[196:199], v6, s[12:15], s98 offen sc1
    s_mov_b32 s98, 704512
    buffer_load_dwordx4 v[200:203], v6, s[12:15], s98 offen sc1
    s_mov_b32 s98, 729088
    buffer_load_dwordx4 v[204:207], v6, s[12:15], s98 offen sc1
    s_mov_b32 s98, 659456
    buffer_load_dwordx4 v[208:211], v6, s[12:15], s98 offen sc1
    s_mov_b32 s98, 684032
    buffer_load_dwordx4 v[212:215], v6, s[12:15], s98 offen sc1
    s_mov_b32 s98, 708608
    buffer_load_dwordx4 v[216:219], v6, s[12:15], s98 offen sc1
    s_mov_b32 s98, 733184
    buffer_load_dwordx4 v[220:223], v6, s[12:15], s98 offen sc1
    s_add_u32 s99, s99, 1
    s_waitcnt vmcnt(0)
    v_cmp_ne_u64 vcc, s[96:97], v[194:195]
    v_cmp_ne_u64 s[100:101], s[96:97], v[198:199]
    s_or_b64 vcc, vcc, s[100:101]
    v_cmp_ne_u64 s[100:101], s[96:97], v[202:203]
    s_or_b64 vcc, vcc, s[100:101]
    v_cmp_ne_u64 s[100:101], s[96:97], v[206:207]
    s_or_b64 vcc, vcc, s[100:101]
    v_cmp_ne_u64 s[100:101], s[96:97], v[210:211]
    s_or_b64 vcc, vcc, s[100:101]
    v_cmp_ne_u64 s[100:101], s[96:97], v[214:215]
    s_or_b64 vcc, vcc, s[100:101]
    v_cmp_ne_u64 s[100:101], s[96:97], v[218:219]
    s_or_b64 vcc, vcc, s[100:101]
    v_cmp_ne_u64 s[100:101], s[96:97], v[222:223]
    s_or_b64 vcc, vcc, s[100:101]
    s_cmp_eq_u64 vcc, 0
    s_cbranch_scc1 PD2
    s_sleep 4
    s_cmp_lt_u32 s99, 50000
    s_cbranch_scc1 PL2
PD2:
    v_add_f32 v192, v192, v196
    v_add_f32 v200, v200, v204
    v_add_f32 v16, v192, v200
    v_add_f32 v193, v193, v197
    v_add_f32 v201, v201, v205
    v_add_f32 v17, v193, v201
    v_cvt_pk_bf16_f32 v11, v16, v17
    v_lshlrev_b32 v16, 16, v11
    v_and_b32 v17, 0xffff0000, v11
    v_add_f32 v208, v208, v212
    v_add_f32 v216, v216, v220
    v_add_f32 v18, v208, v216
    v_add_f32 v209, v209, v213
    v_add_f32 v217, v217, v221
    v_add_f32 v19, v209, v217
    v_cvt_pk_bf16_f32 v11, v18, v19
    v_lshlrev_b32 v18, 16, v11
    v_and_b32 v19, 0xffff0000, v11
    v_add_f32 v18, 1.0, v18
    v_add_f32 v19, 1.0, v19
    v_cvt_pk_bf16_f32 v11, v18, v19
    v_lshlrev_b32 v18, 16, v11
    v_and_b32 v19, 0xffff0000, v11
    v_lshrrev_b32 v6, 1, v6
    v_add_u32 v6, 155648, v6
    ds_write_b64 v6, v[16:17]
    ds_write_b64 v6, v[18:19] offset:2048
    s_waitcnt lgkmcnt(0)
    s_barrier
    ds_read_b128 v[16:19], v5 offset:0
    ds_read_b128 v[20:23], v5 offset:16
    ds_read_b128 v[24:27], v5 offset:2048
    ds_read_b128 v[28:31], v5 offset:2064
    s_waitcnt lgkmcnt(0)
    v_pk_fma_f32 v[64:65], v[64:65], v[24:25], v[16:17]
    v_pk_fma_f32 v[66:67], v[66:67], v[26:27], v[18:19]
    v_pk_fma_f32 v[68:69], v[68:69], v[28:29], v[20:21]
    v_pk_fma_f32 v[70:71], v[70:71], v[30:31], v[22:23]
    v_cvt_pk_bf16_f32 v64, v64, v65
    v_cvt_pk_bf16_f32 v65, v66, v67
    v_cvt_pk_bf16_f32 v66, v68, v69
    v_cvt_pk_bf16_f32 v67, v70, v71
    v_xor_b32 v11, 0, v10
    ds_write_b128 v11, v[64:67] offset:0
    v_pk_fma_f32 v[72:73], v[72:73], v[24:25], v[16:17]
    v_pk_fma_f32 v[74:75], v[74:75], v[26:27], v[18:19]
    v_pk_fma_f32 v[76:77], v[76:77], v[28:29], v[20:21]
    v_pk_fma_f32 v[78:79], v[78:79], v[30:31], v[22:23]
    v_cvt_pk_bf16_f32 v72, v72, v73
    v_cvt_pk_bf16_f32 v73, v74, v75
    v_cvt_pk_bf16_f32 v74, v76, v77
    v_cvt_pk_bf16_f32 v75, v78, v79
    v_xor_b32 v11, 16, v10
    ds_write_b128 v11, v[72:75] offset:0
    v_pk_fma_f32 v[80:81], v[80:81], v[24:25], v[16:17]
    v_pk_fma_f32 v[82:83], v[82:83], v[26:27], v[18:19]
    v_pk_fma_f32 v[84:85], v[84:85], v[28:29], v[20:21]
    v_pk_fma_f32 v[86:87], v[86:87], v[30:31], v[22:23]
    v_cvt_pk_bf16_f32 v80, v80, v81
    v_cvt_pk_bf16_f32 v81, v82, v83
    v_cvt_pk_bf16_f32 v82, v84, v85
    v_cvt_pk_bf16_f32 v83, v86, v87
    v_xor_b32 v11, 32, v10
    ds_write_b128 v11, v[80:83] offset:0
    v_pk_fma_f32 v[88:89], v[88:89], v[24:25], v[16:17]
    v_pk_fma_f32 v[90:91], v[90:91], v[26:27], v[18:19]
    v_pk_fma_f32 v[92:93], v[92:93], v[28:29], v[20:21]
    v_pk_fma_f32 v[94:95], v[94:95], v[30:31], v[22:23]
    v_cvt_pk_bf16_f32 v88, v88, v89
    v_cvt_pk_bf16_f32 v89, v90, v91
    v_cvt_pk_bf16_f32 v90, v92, v93
    v_cvt_pk_bf16_f32 v91, v94, v95
    v_xor_b32 v11, 48, v10
    ds_write_b128 v11, v[88:91] offset:0
    v_pk_fma_f32 v[96:97], v[96:97], v[24:25], v[16:17]
    v_pk_fma_f32 v[98:99], v[98:99], v[26:27], v[18:19]
    v_pk_fma_f32 v[100:101], v[100:101], v[28:29], v[20:21]
    v_pk_fma_f32 v[102:103], v[102:103], v[30:31], v[22:23]
    v_cvt_pk_bf16_f32 v96, v96, v97
    v_cvt_pk_bf16_f32 v97, v98, v99
    v_cvt_pk_bf16_f32 v98, v100, v101
    v_cvt_pk_bf16_f32 v99, v102, v103
    v_xor_b32 v11, 64, v10
    ds_write_b128 v11, v[96:99] offset:0
    v_pk_fma_f32 v[104:105], v[104:105], v[24:25], v[16:17]
    v_pk_fma_f32 v[106:107], v[106:107], v[26:27], v[18:19]
    v_pk_fma_f32 v[108:109], v[108:109], v[28:29], v[20:21]
    v_pk_fma_f32 v[110:111], v[110:111], v[30:31], v[22:23]
    v_cvt_pk_bf16_f32 v104, v104, v105
    v_cvt_pk_bf16_f32 v105, v106, v107
    v_cvt_pk_bf16_f32 v106, v108, v109
    v_cvt_pk_bf16_f32 v107, v110, v111
    v_xor_b32 v11, 80, v10
    ds_write_b128 v11, v[104:107] offset:0
    v_pk_fma_f32 v[112:113], v[112:113], v[24:25], v[16:17]
    v_pk_fma_f32 v[114:115], v[114:115], v[26:27], v[18:19]
    v_pk_fma_f32 v[116:117], v[116:117], v[28:29], v[20:21]
    v_pk_fma_f32 v[118:119], v[118:119], v[30:31], v[22:23]
    v_cvt_pk_bf16_f32 v112, v112, v113
    v_cvt_pk_bf16_f32 v113, v114, v115
    v_cvt_pk_bf16_f32 v114, v116, v117
    v_cvt_pk_bf16_f32 v115, v118, v119
    v_xor_b32 v11, 96, v10
    ds_write_b128 v11, v[112:115] offset:0
    v_pk_fma_f32 v[120:121], v[120:121], v[24:25], v[16:17]
    v_pk_fma_f32 v[122:123], v[122:123], v[26:27], v[18:19]
    v_pk_fma_f32 v[124:125], v[124:125], v[28:29], v[20:21]
    v_pk_fma_f32 v[126:127], v[126:127], v[30:31], v[22:23]
    v_cvt_pk_bf16_f32 v120, v120, v121
    v_cvt_pk_bf16_f32 v121, v122, v123
    v_cvt_pk_bf16_f32 v122, v124, v125
    v_cvt_pk_bf16_f32 v123, v126, v127
    v_xor_b32 v11, 112, v10
    ds_write_b128 v11, v[120:123] offset:0
    v_pk_fma_f32 v[128:129], v[128:129], v[24:25], v[16:17]
    v_pk_fma_f32 v[130:131], v[130:131], v[26:27], v[18:19]
    v_pk_fma_f32 v[132:133], v[132:133], v[28:29], v[20:21]
    v_pk_fma_f32 v[134:135], v[134:135], v[30:31], v[22:23]
    v_cvt_pk_bf16_f32 v128, v128, v129
    v_cvt_pk_bf16_f32 v129, v130, v131
    v_cvt_pk_bf16_f32 v130, v132, v133
    v_cvt_pk_bf16_f32 v131, v134, v135
    v_xor_b32 v11, 0, v10
    ds_write_b128 v11, v[128:131] offset:128
    v_pk_fma_f32 v[136:137], v[136:137], v[24:25], v[16:17]
    v_pk_fma_f32 v[138:139], v[138:139], v[26:27], v[18:19]
    v_pk_fma_f32 v[140:141], v[140:141], v[28:29], v[20:21]
    v_pk_fma_f32 v[142:143], v[142:143], v[30:31], v[22:23]
    v_cvt_pk_bf16_f32 v136, v136, v137
    v_cvt_pk_bf16_f32 v137, v138, v139
    v_cvt_pk_bf16_f32 v138, v140, v141
    v_cvt_pk_bf16_f32 v139, v142, v143
    v_xor_b32 v11, 16, v10
    ds_write_b128 v11, v[136:139] offset:128
    v_pk_fma_f32 v[144:145], v[144:145], v[24:25], v[16:17]
    v_pk_fma_f32 v[146:147], v[146:147], v[26:27], v[18:19]
    v_pk_fma_f32 v[148:149], v[148:149], v[28:29], v[20:21]
    v_pk_fma_f32 v[150:151], v[150:151], v[30:31], v[22:23]
    v_cvt_pk_bf16_f32 v144, v144, v145
    v_cvt_pk_bf16_f32 v145, v146, v147
    v_cvt_pk_bf16_f32 v146, v148, v149
    v_cvt_pk_bf16_f32 v147, v150, v151
    v_xor_b32 v11, 32, v10
    ds_write_b128 v11, v[144:147] offset:128
    v_pk_fma_f32 v[152:153], v[152:153], v[24:25], v[16:17]
    v_pk_fma_f32 v[154:155], v[154:155], v[26:27], v[18:19]
    v_pk_fma_f32 v[156:157], v[156:157], v[28:29], v[20:21]
    v_pk_fma_f32 v[158:159], v[158:159], v[30:31], v[22:23]
    v_cvt_pk_bf16_f32 v152, v152, v153
    v_cvt_pk_bf16_f32 v153, v154, v155
    v_cvt_pk_bf16_f32 v154, v156, v157
    v_cvt_pk_bf16_f32 v155, v158, v159
    v_xor_b32 v11, 48, v10
    ds_write_b128 v11, v[152:155] offset:128
    v_pk_fma_f32 v[160:161], v[160:161], v[24:25], v[16:17]
    v_pk_fma_f32 v[162:163], v[162:163], v[26:27], v[18:19]
    v_pk_fma_f32 v[164:165], v[164:165], v[28:29], v[20:21]
    v_pk_fma_f32 v[166:167], v[166:167], v[30:31], v[22:23]
    v_cvt_pk_bf16_f32 v160, v160, v161
    v_cvt_pk_bf16_f32 v161, v162, v163
    v_cvt_pk_bf16_f32 v162, v164, v165
    v_cvt_pk_bf16_f32 v163, v166, v167
    v_xor_b32 v11, 64, v10
    ds_write_b128 v11, v[160:163] offset:128
    v_pk_fma_f32 v[168:169], v[168:169], v[24:25], v[16:17]
    v_pk_fma_f32 v[170:171], v[170:171], v[26:27], v[18:19]
    v_pk_fma_f32 v[172:173], v[172:173], v[28:29], v[20:21]
    v_pk_fma_f32 v[174:175], v[174:175], v[30:31], v[22:23]
    v_cvt_pk_bf16_f32 v168, v168, v169
    v_cvt_pk_bf16_f32 v169, v170, v171
    v_cvt_pk_bf16_f32 v170, v172, v173
    v_cvt_pk_bf16_f32 v171, v174, v175
    v_xor_b32 v11, 80, v10
    ds_write_b128 v11, v[168:171] offset:128
    v_pk_fma_f32 v[176:177], v[176:177], v[24:25], v[16:17]
    v_pk_fma_f32 v[178:179], v[178:179], v[26:27], v[18:19]
    v_pk_fma_f32 v[180:181], v[180:181], v[28:29], v[20:21]
    v_pk_fma_f32 v[182:183], v[182:183], v[30:31], v[22:23]
    v_cvt_pk_bf16_f32 v176, v176, v177
    v_cvt_pk_bf16_f32 v177, v178, v179
    v_cvt_pk_bf16_f32 v178, v180, v181
    v_cvt_pk_bf16_f32 v179, v182, v183
    v_xor_b32 v11, 96, v10
    ds_write_b128 v11, v[176:179] offset:128
    v_pk_fma_f32 v[184:185], v[184:185], v[24:25], v[16:17]
    v_pk_fma_f32 v[186:187], v[186:187], v[26:27], v[18:19]
    v_pk_fma_f32 v[188:189], v[188:189], v[28:29], v[20:21]
    v_pk_fma_f32 v[190:191], v[190:191], v[30:31], v[22:23]
    v_cvt_pk_bf16_f32 v184, v184, v185
    v_cvt_pk_bf16_f32 v185, v186, v187
    v_cvt_pk_bf16_f32 v186, v188, v189
    v_cvt_pk_bf16_f32 v187, v190, v191
    v_xor_b32 v11, 112, v10
    ds_write_b128 v11, v[184:187] offset:128
    s_waitcnt lgkmcnt(0)
    s_barrier
    ds_read_b128 v[16:19], v12 offset:0
    ds_read_b64_tr_b16 v[20:21], v8 offset:0
    ds_read_b64_tr_b16 v[22:23], v8 offset:512
    ds_read_b64_tr_b16 v[24:25], v8 offset:2048
    ds_read_b64_tr_b16 v[26:27], v8 offset:2560
    ds_read_b64_tr_b16 v[28:29], v8 offset:4096
    ds_read_b64_tr_b16 v[30:31], v8 offset:4608
    ds_read_b128 v[32:35], v13 offset:1024
    ds_read_b64_tr_b16 v[36:37], v8 offset:6144
    ds_read_b64_tr_b16 v[38:39], v8 offset:6656
    ds_read_b64_tr_b16 v[40:41], v8 offset:8192
    ds_read_b64_tr_b16 v[42:43], v8 offset:8704
    ds_read_b64_tr_b16 v[44:45], v8 offset:10240
    ds_read_b64_tr_b16 v[46:47], v8 offset:10752
    s_waitcnt lgkmcnt(7)
    v_mfma_f32_32x32x16_bf16 v[64:79], v[20:23], v[16:19], 0
    ds_read_b128 v[48:51], v14 offset:2048
    ds_read_b64_tr_b16 v[52:53], v8 offset:12288
    ds_read_b64_tr_b16 v[54:55], v8 offset:12800
    v_mfma_f32_32x32x16_bf16 v[80:95], v[24:27], v[16:19], 0
    ds_read_b64_tr_b16 v[56:57], v8 offset:14336
    ds_read_b64_tr_b16 v[58:59], v8 offset:14848
    v_mfma_f32_32x32x16_bf16 v[96:111], v[16:19], v[28:31], 0
    ds_read_b64_tr_b16 v[60:61], v8 offset:16384
    ds_read_b64_tr_b16 v[62:63], v8 offset:16896
    v_lshrrev_b32 v172, 3, v1
    v_and_b32 v173, 7, v1
    v_lshlrev_b32 v173, 4, v173
    v_and_b32 v174, 16, v1
    v_lshlrev_b32 v174, 2, v174
    v_xor_b32 v173, v173, v174
    s_lshl_b32 s56, s4, 12
    s_add_u32 s56, s56, 139264
    s_cmp_ge_u32 s2, 224
    s_cbranch_scc1 JI_A1
    s_load_dwordx2 s[48:49], s[0:1], 32
    s_load_dwordx2 s[52:53], s[0:1], 40
    s_mov_b32 s50, 1835008
    s_mov_b32 s51, 0x00020000
    s_mov_b32 s54, 1835008
    s_mov_b32 s55, 0x00020000
    s_lshr_b32 s57, s2, 3
    s_and_b32 s58, s2, 7
    s_lshl_b32 s58, s58, 2
    s_add_u32 s58, s58, s4
    v_mul_u32_u24 v172, 3584, v172
    v_xor_b32 v174, 32, v173
    v_add_u32 v174, v172, v174
    v_add_u32 v172, v172, v173
    s_mul_i32 s59, s58, 57344
    s_lshl_b32 s60, s57, 7
    s_add_u32 s59, s59, s60
    s_add_u32 s60, s59, 28672
    s_waitcnt lgkmcnt(0)
    s_add_u32 m0, s56, 0
    s_nop 0
    buffer_load_dwordx4 v172, s[48:51], s59 offen lds
    s_add_u32 m0, s56, 1024
    s_nop 0
    buffer_load_dwordx4 v172, s[48:51], s60 offen lds
    s_add_u32 m0, s56, 2048
    s_nop 0
    buffer_load_dwordx4 v174, s[52:55], s59 offen lds
    s_add_u32 m0, s56, 3072
    s_nop 0
    buffer_load_dwordx4 v174, s[52:55], s60 offen lds
    s_lshl_b32 s59, s57, 2
    s_add_u32 s59, s59, 0
    s_mul_i32 s60, s59, 9363
    s_lshr_b32 s60, s60, 16
    s_mul_i32 s61, s60, 7
    s_sub_u32 s59, s59, s61
    s_lshl_b32 s61, s58, 2
    s_mul_i32 s62, s58, 3
    s_add_u32 s62, s62, 124
    s_cmp_lt_u32 s59, 4
    s_cselect_b32 s61, s61, s62
    s_add_u32 s61, s61, s59
    s_mul_i32 s60, s60, 224
    s_add_u32 s61, s61, s60
    s_lshl_b32 s61, s61, 10
    s_add_u32 s44, s61, 26214400
    s_lshl_b32 s59, s57, 2
    s_add_u32 s59, s59, 1
    s_mul_i32 s60, s59, 9363
    s_lshr_b32 s60, s60, 16
    s_mul_i32 s61, s60, 7
    s_sub_u32 s59, s59, s61
    s_lshl_b32 s61, s58, 2
    s_mul_i32 s62, s58, 3
    s_add_u32 s62, s62, 124
    s_cmp_lt_u32 s59, 4
    s_cselect_b32 s61, s61, s62
    s_add_u32 s61, s61, s59
    s_mul_i32 s60, s60, 224
    s_add_u32 s61, s61, s60
    s_lshl_b32 s61, s61, 10
    s_add_u32 s45, s61, 26214400
    s_lshl_b32 s59, s57, 2
    s_add_u32 s59, s59, 2
    s_mul_i32 s60, s59, 9363
    s_lshr_b32 s60, s60, 16
    s_mul_i32 s61, s60, 7
    s_sub_u32 s59, s59, s61
    s_lshl_b32 s61, s58, 2
    s_mul_i32 s62, s58, 3
    s_add_u32 s62, s62, 124
    s_cmp_lt_u32 s59, 4
    s_cselect_b32 s61, s61, s62
    s_add_u32 s61, s61, s59
    s_mul_i32 s60, s60, 224
    s_add_u32 s61, s61, s60
    s_lshl_b32 s61, s61, 10
    s_add_u32 s46, s61, 26214400
    s_lshl_b32 s59, s57, 2
    s_add_u32 s59, s59, 3
    s_mul_i32 s60, s59, 9363
    s_lshr_b32 s60, s60, 16
    s_mul_i32 s61, s60, 7
    s_sub_u32 s59, s59, s61
    s_lshl_b32 s61, s58, 2
    s_mul_i32 s62, s58, 3
    s_add_u32 s62, s62, 124
    s_cmp_lt_u32 s59, 4
    s_cselect_b32 s61, s61, s62
    s_add_u32 s61, s61, s59
    s_mul_i32 s60, s60, 224
    s_add_u32 s61, s61, s60
    s_lshl_b32 s61, s61, 10
    s_add_u32 s47, s61, 26214400
    s_branch JI_A2
JI_A1:
    s_load_dwordx2 s[48:49], s[0:1], 16
    s_mov_b32 s50, 524288
    s_mov_b32 s51, 0x00020000
    s_sub_u32 s57, s2, 224
    s_and_b32 s58, s57, 7
    s_lshr_b32 s57, s57, 3
    s_lshl_b32 s57, s57, 3
    s_lshl_b32 s59, s4, 1
    s_add_u32 s57, s57, s59
    s_mul_i32 s44, s58, 65536
    s_lshl_b32 s59, s57, 10
    s_add_u32 s44, s44, s59
    s_add_u32 s44, s44, 25690112
    s_add_u32 s45, s44, 32768
    s_add_u32 s46, s44, 1024
    s_add_u32 s47, s45, 1024
    s_lshl_b32 s59, s57, 14
    s_lshl_b32 s60, s58, 7
    s_add_u32 s59, s59, s60
    v_lshl_add_u32 v172, v172, 10, v173
    s_waitcnt lgkmcnt(0)
    s_add_u32 m0, s56, 0
    s_nop 0
    buffer_load_dwordx4 v172, s[48:51], s59 offen lds
    s_add_u32 s59, s59, 8192
    s_add_u32 m0, s56, 1024
    s_nop 0
    buffer_load_dwordx4 v172, s[48:51], s59 offen lds
    s_add_u32 s59, s59, 8192
    s_add_u32 m0, s56, 2048
    s_nop 0
    buffer_load_dwordx4 v172, s[48:51], s59 offen lds
    s_add_u32 s59, s59, 8192
    s_add_u32 m0, s56, 3072
    s_nop 0
    buffer_load_dwordx4 v172, s[48:51], s59 offen lds
    s_add_u32 s59, s59, 8192
JI_A2:
    v_mfma_f32_32x32x16_bf16 v[64:79], v[36:39], v[32:35], v[64:79]
    ds_read_b128 v[16:19], v15 offset:3072
    ds_read_b64_tr_b16 v[20:21], v8 offset:18432
    ds_read_b64_tr_b16 v[22:23], v8 offset:18944
    v_mfma_f32_32x32x16_bf16 v[80:95], v[40:43], v[32:35], v[80:95]
    ds_read_b64_tr_b16 v[24:25], v8 offset:20480
    ds_read_b64_tr_b16 v[26:27], v8 offset:20992
    v_mfma_f32_32x32x16_bf16 v[96:111], v[32:35], v[44:47], v[96:111]
    ds_read_b64_tr_b16 v[28:29], v8 offset:22528
    ds_read_b64_tr_b16 v[30:31], v8 offset:23040
    s_barrier
    v_mfma_f32_32x32x16_bf16 v[64:79], v[52:55], v[48:51], v[64:79]
    ds_read_b128 v[32:35], v12 offset:4096
    ds_read_b64_tr_b16 v[36:37], v8 offset:24576
    ds_read_b64_tr_b16 v[38:39], v8 offset:25088
    s_add_u32 m0, s35, 0
    s_add_u32 s37, s34, 0
    buffer_load_dwordx4 v7, s[24:27], s37 offen lds
    v_mfma_f32_32x32x16_bf16 v[80:95], v[56:59], v[48:51], v[80:95]
    ds_read_b64_tr_b16 v[40:41], v8 offset:26624
    ds_read_b64_tr_b16 v[42:43], v8 offset:27136
    s_add_u32 m0, s35, 2048
    s_add_u32 s37, s34, 1024
    buffer_load_dwordx4 v7, s[24:27], s37 offen lds
    v_mfma_f32_32x32x16_bf16 v[96:111], v[48:51], v[60:63], v[96:111]
    ds_read_b64_tr_b16 v[44:45], v8 offset:28672
    ds_read_b64_tr_b16 v[46:47], v8 offset:29184
    s_add_u32 m0, s35, 4096
    s_add_u32 s37, s34, 2048
    buffer_load_dwordx4 v7, s[24:27], s37 offen lds
    s_add_u32 s34, s34, 98304
    s_waitcnt lgkmcnt(7)
    v_mfma_f32_32x32x16_bf16 v[64:79], v[20:23], v[16:19], v[64:79]
    ds_read_b128 v[48:51], v13 offset:5120
    ds_read_b64_tr_b16 v[52:53], v8 offset:30720
    ds_read_b64_tr_b16 v[54:55], v8 offset:31232
    v_mfma_f32_32x32x16_bf16 v[80:95], v[24:27], v[16:19], v[80:95]
    ds_read_b64_tr_b16 v[56:57], v8 offset:32768
    ds_read_b64_tr_b16 v[58:59], v8 offset:33280
    v_mfma_f32_32x32x16_bf16 v[96:111], v[16:19], v[28:31], v[96:111]
    ds_read_b64_tr_b16 v[60:61], v8 offset:34816
    ds_read_b64_tr_b16 v[62:63], v8 offset:35328
    s_barrier
    s_waitcnt lgkmcnt(7)
    v_mfma_f32_32x32x16_bf16 v[64:79], v[36:39], v[32:35], v[64:79]
    ds_read_b128 v[16:19], v14 offset:6144
    ds_read_b64_tr_b16 v[20:21], v9 offset:0
    ds_read_b64_tr_b16 v[22:23], v9 offset:512
    s_add_u32 m0, s35, 12288
    s_add_u32 s37, s34, 0
    buffer_load_dwordx4 v7, s[24:27], s37 offen lds
    v_mfma_f32_32x32x16_bf16 v[80:95], v[40:43], v[32:35], v[80:95]
    ds_read_b64_tr_b16 v[24:25], v9 offset:2048
    ds_read_b64_tr_b16 v[26:27], v9 offset:2560
    s_add_u32 m0, s35, 14336
    s_add_u32 s37, s34, 1024
    buffer_load_dwordx4 v7, s[24:27], s37 offen lds
    v_mfma_f32_32x32x16_bf16 v[96:111], v[32:35], v[44:47], v[96:111]
    ds_read_b64_tr_b16 v[28:29], v9 offset:4096
    ds_read_b64_tr_b16 v[30:31], v9 offset:4608
    s_add_u32 m0, s35, 16384
    s_add_u32 s37, s34, 2048
    buffer_load_dwordx4 v7, s[24:27], s37 offen lds
    s_add_u32 s34, s34, 98304
    s_waitcnt lgkmcnt(7)
    v_mfma_f32_32x32x16_bf16 v[64:79], v[52:55], v[48:51], v[64:79]
    ds_read_b128 v[32:35], v15 offset:7168
    ds_read_b64_tr_b16 v[36:37], v9 offset:6144
    ds_read_b64_tr_b16 v[38:39], v9 offset:6656
    v_mfma_f32_32x32x16_bf16 v[80:95], v[56:59], v[48:51], v[80:95]
    ds_read_b64_tr_b16 v[40:41], v9 offset:8192
    ds_read_b64_tr_b16 v[42:43], v9 offset:8704
    v_mfma_f32_32x32x16_bf16 v[96:111], v[48:51], v[60:63], v[96:111]
    ds_read_b64_tr_b16 v[44:45], v9 offset:10240
    ds_read_b64_tr_b16 v[46:47], v9 offset:10752
    s_barrier
    s_waitcnt lgkmcnt(7)
    v_mfma_f32_32x32x16_bf16 v[64:79], v[20:23], v[16:19], v[64:79]
    ds_read_b128 v[48:51], v12 offset:8192
    ds_read_b64_tr_b16 v[52:53], v9 offset:12288
    ds_read_b64_tr_b16 v[54:55], v9 offset:12800
    s_add_u32 m0, s35, 24576
    s_add_u32 s37, s34, 0
    buffer_load_dwordx4 v7, s[24:27], s37 offen lds
    v_mfma_f32_32x32x16_bf16 v[80:95], v[24:27], v[16:19], v[80:95]
    ds_read_b64_tr_b16 v[56:57], v9 offset:14336
    ds_read_b64_tr_b16 v[58:59], v9 offset:14848
    s_add_u32 m0, s35, 26624
    s_add_u32 s37, s34, 1024
    buffer_load_dwordx4 v7, s[24:27], s37 offen lds
    v_mfma_f32_32x32x16_bf16 v[96:111], v[16:19], v[28:31], v[96:111]
    ds_read_b64_tr_b16 v[60:61], v9 offset:16384
    ds_read_b64_tr_b16 v[62:63], v9 offset:16896
    s_add_u32 m0, s35, 28672
    s_add_u32 s37, s34, 2048
    buffer_load_dwordx4 v7, s[24:27], s37 offen lds
    s_add_u32 s34, s34, 98304
    s_waitcnt lgkmcnt(7)
    v_mfma_f32_32x32x16_bf16 v[64:79], v[36:39], v[32:35], v[64:79]
    ds_read_b128 v[16:19], v13 offset:9216
    ds_read_b64_tr_b16 v[20:21], v9 offset:18432
    ds_read_b64_tr_b16 v[22:23], v9 offset:18944
    v_mfma_f32_32x32x16_bf16 v[80:95], v[40:43], v[32:35], v[80:95]
    ds_read_b64_tr_b16 v[24:25], v9 offset:20480
    ds_read_b64_tr_b16 v[26:27], v9 offset:20992
    v_mfma_f32_32x32x16_bf16 v[96:111], v[32:35], v[44:47], v[96:111]
    ds_read_b64_tr_b16 v[28:29], v9 offset:22528
    ds_read_b64_tr_b16 v[30:31], v9 offset:23040
    s_barrier
    s_waitcnt lgkmcnt(7)
    v_mfma_f32_32x32x16_bf16 v[64:79], v[52:55], v[48:51], v[64:79]
    ds_read_b128 v[32:35], v14 offset:10240
    ds_read_b64_tr_b16 v[36:37], v9 offset:24576
    ds_read_b64_tr_b16 v[38:39], v9 offset:25088
    s_add_u32 m0, s35, 36864
    s_add_u32 s37, s34, 0
    buffer_load_dwordx4 v7, s[24:27], s37 offen lds
    v_mfma_f32_32x32x16_bf16 v[80:95], v[56:59], v[48:51], v[80:95]
    ds_read_b64_tr_b16 v[40:41], v9 offset:26624
    ds_read_b64_tr_b16 v[42:43], v9 offset:27136
    s_add_u32 m0, s35, 38912
    s_add_u32 s37, s34, 1024
    buffer_load_dwordx4 v7, s[24:27], s37 offen lds
    v_mfma_f32_32x32x16_bf16 v[96:111], v[48:51], v[60:63], v[96:111]
    ds_read_b64_tr_b16 v[44:45], v9 offset:28672
    ds_read_b64_tr_b16 v[46:47], v9 offset:29184
    s_add_u32 m0, s35, 40960
    s_add_u32 s37, s34, 2048
    buffer_load_dwordx4 v7, s[24:27], s37 offen lds
    s_add_u32 s34, s34, 98304
    s_waitcnt lgkmcnt(7)
    v_mfma_f32_32x32x16_bf16 v[64:79], v[20:23], v[16:19], v[64:79]
    ds_read_b128 v[48:51], v15 offset:11264
    ds_read_b64_tr_b16 v[52:53], v9 offset:30720
    ds_read_b64_tr_b16 v[54:55], v9 offset:31232
    v_mfma_f32_32x32x16_bf16 v[80:95], v[24:27], v[16:19], v[80:95]
    ds_read_b64_tr_b16 v[56:57], v9 offset:32768
    ds_read_b64_tr_b16 v[58:59], v9 offset:33280
    v_mfma_f32_32x32x16_bf16 v[96:111], v[16:19], v[28:31], v[96:111]
    ds_read_b64_tr_b16 v[60:61], v9 offset:34816
    ds_read_b64_tr_b16 v[62:63], v9 offset:35328
    s_waitcnt vmcnt(9)
    s_barrier
    s_waitcnt lgkmcnt(7)
    v_mfma_f32_32x32x16_bf16 v[64:79], v[36:39], v[32:35], v[64:79]
    ds_read_b128 v[16:19], v12 offset:12288
    ds_read_b64_tr_b16 v[20:21], v8 offset:0
    ds_read_b64_tr_b16 v[22:23], v8 offset:512
    s_add_u32 m0, s35, 49152
    s_add_u32 s37, s34, 0
    buffer_load_dwordx4 v7, s[24:27], s37 offen lds
    v_mfma_f32_32x32x16_bf16 v[80:95], v[40:43], v[32:35], v[80:95]
    ds_read_b64_tr_b16 v[24:25], v8 offset:2048
    ds_read_b64_tr_b16 v[26:27], v8 offset:2560
    s_add_u32 m0, s35, 51200
    s_add_u32 s37, s34, 1024
    buffer_load_dwordx4 v7, s[24:27], s37 offen lds
    v_mfma_f32_32x32x16_bf16 v[96:111], v[32:35], v[44:47], v[96:111]
    ds_read_b64_tr_b16 v[28:29], v8 offset:4096
    ds_read_b64_tr_b16 v[30:31], v8 offset:4608
    s_add_u32 m0, s35, 53248
    s_add_u32 s37, s34, 2048
    buffer_load_dwordx4 v7, s[24:27], s37 offen lds
    s_add_u32 s34, s34, 98304
    s_waitcnt lgkmcnt(7)
    v_mfma_f32_32x32x16_bf16 v[64:79], v[52:55], v[48:51], v[64:79]
    ds_read_b128 v[32:35], v13 offset:13312
    ds_read_b64_tr_b16 v[36:37], v8 offset:6144
    ds_read_b64_tr_b16 v[38:39], v8 offset:6656
    v_mfma_f32_32x32x16_bf16 v[80:95], v[56:59], v[48:51], v[80:95]
    ds_read_b64_tr_b16 v[40:41], v8 offset:8192
    ds_read_b64_tr_b16 v[42:43], v8 offset:8704
    v_mfma_f32_32x32x16_bf16 v[96:111], v[48:51], v[60:63], v[96:111]
    ds_read_b64_tr_b16 v[44:45], v8 offset:10240
    ds_read_b64_tr_b16 v[46:47], v8 offset:10752
    s_waitcnt vmcnt(9)
    s_barrier
    s_waitcnt lgkmcnt(7)
    v_mfma_f32_32x32x16_bf16 v[64:79], v[20:23], v[16:19], v[64:79]
    ds_read_b128 v[48:51], v14 offset:14336
    ds_read_b64_tr_b16 v[52:53], v8 offset:12288
    ds_read_b64_tr_b16 v[54:55], v8 offset:12800
    s_add_u32 m0, s35, 61440
    s_add_u32 s37, s34, 0
    buffer_load_dwordx4 v7, s[24:27], s37 offen lds
    v_mfma_f32_32x32x16_bf16 v[80:95], v[24:27], v[16:19], v[80:95]
    ds_read_b64_tr_b16 v[56:57], v8 offset:14336
    ds_read_b64_tr_b16 v[58:59], v8 offset:14848
    s_add_u32 m0, s35, 63488
    s_add_u32 s37, s34, 1024
    buffer_load_dwordx4 v7, s[24:27], s37 offen lds
    v_mfma_f32_32x32x16_bf16 v[96:111], v[16:19], v[28:31], v[96:111]
    ds_read_b64_tr_b16 v[60:61], v8 offset:16384
    ds_read_b64_tr_b16 v[62:63], v8 offset:16896
    s_add_u32 m0, s35, 65536
    s_add_u32 s37, s34, 2048
    buffer_load_dwordx4 v7, s[24:27], s37 offen lds
    s_add_u32 s34, s34, 98304
    s_waitcnt lgkmcnt(7)
    v_mfma_f32_32x32x16_bf16 v[64:79], v[36:39], v[32:35], v[64:79]
    ds_read_b128 v[16:19], v15 offset:15360
    ds_read_b64_tr_b16 v[20:21], v8 offset:18432
    ds_read_b64_tr_b16 v[22:23], v8 offset:18944
    v_mfma_f32_32x32x16_bf16 v[80:95], v[40:43], v[32:35], v[80:95]
    ds_read_b64_tr_b16 v[24:25], v8 offset:20480
    ds_read_b64_tr_b16 v[26:27], v8 offset:20992
    v_mfma_f32_32x32x16_bf16 v[96:111], v[32:35], v[44:47], v[96:111]
    ds_read_b64_tr_b16 v[28:29], v8 offset:22528
    ds_read_b64_tr_b16 v[30:31], v8 offset:23040
    s_waitcnt vmcnt(9)
    s_barrier
    s_waitcnt lgkmcnt(7)
    v_mfma_f32_32x32x16_bf16 v[64:79], v[52:55], v[48:51], v[64:79]
    ds_read_b128 v[32:35], v12 offset:16384
    ds_read_b64_tr_b16 v[36:37], v8 offset:24576
    ds_read_b64_tr_b16 v[38:39], v8 offset:25088
    s_add_u32 m0, s35, 0
    s_add_u32 s37, s34, 0
    buffer_load_dwordx4 v7, s[24:27], s37 offen lds
    v_mfma_f32_32x32x16_bf16 v[80:95], v[56:59], v[48:51], v[80:95]
    ds_read_b64_tr_b16 v[40:41], v8 offset:26624
    ds_read_b64_tr_b16 v[42:43], v8 offset:27136
    s_add_u32 m0, s35, 2048
    s_add_u32 s37, s34, 1024
    buffer_load_dwordx4 v7, s[24:27], s37 offen lds
    v_mfma_f32_32x32x16_bf16 v[96:111], v[48:51], v[60:63], v[96:111]
    ds_read_b64_tr_b16 v[44:45], v8 offset:28672
    ds_read_b64_tr_b16 v[46:47], v8 offset:29184
    s_add_u32 m0, s35, 4096
    s_add_u32 s37, s34, 2048
    buffer_load_dwordx4 v7, s[24:27], s37 offen lds
    s_add_u32 s34, s34, 98304
    s_waitcnt lgkmcnt(7)
    v_mfma_f32_32x32x16_bf16 v[64:79], v[20:23], v[16:19], v[64:79]
    ds_read_b128 v[48:51], v13 offset:17408
    ds_read_b64_tr_b16 v[52:53], v8 offset:30720
    ds_read_b64_tr_b16 v[54:55], v8 offset:31232
    v_mfma_f32_32x32x16_bf16 v[80:95], v[24:27], v[16:19], v[80:95]
    ds_read_b64_tr_b16 v[56:57], v8 offset:32768
    ds_read_b64_tr_b16 v[58:59], v8 offset:33280
    v_mfma_f32_32x32x16_bf16 v[96:111], v[16:19], v[28:31], v[96:111]
    ds_read_b64_tr_b16 v[60:61], v8 offset:34816
    ds_read_b64_tr_b16 v[62:63], v8 offset:35328
    s_waitcnt vmcnt(9)
    s_barrier
    s_waitcnt lgkmcnt(7)
    v_mfma_f32_32x32x16_bf16 v[64:79], v[36:39], v[32:35], v[64:79]
    ds_read_b128 v[16:19], v14 offset:18432
    ds_read_b64_tr_b16 v[20:21], v9 offset:0
    ds_read_b64_tr_b16 v[22:23], v9 offset:512
    s_add_u32 m0, s35, 12288
    s_add_u32 s37, s34, 0
    buffer_load_dwordx4 v7, s[24:27], s37 offen lds
    v_mfma_f32_32x32x16_bf16 v[80:95], v[40:43], v[32:35], v[80:95]
    ds_read_b64_tr_b16 v[24:25], v9 offset:2048
    ds_read_b64_tr_b16 v[26:27], v9 offset:2560
    s_add_u32 m0, s35, 14336
    s_add_u32 s37, s34, 1024
    buffer_load_dwordx4 v7, s[24:27], s37 offen lds
    v_mfma_f32_32x32x16_bf16 v[96:111], v[32:35], v[44:47], v[96:111]
    ds_read_b64_tr_b16 v[28:29], v9 offset:4096
    ds_read_b64_tr_b16 v[30:31], v9 offset:4608
    s_add_u32 m0, s35, 16384
    s_add_u32 s37, s34, 2048
    buffer_load_dwordx4 v7, s[24:27], s37 offen lds
    s_add_u32 s34, s34, 98304
    s_waitcnt lgkmcnt(7)
    v_mfma_f32_32x32x16_bf16 v[64:79], v[52:55], v[48:51], v[64:79]
    ds_read_b128 v[32:35], v15 offset:19456
    ds_read_b64_tr_b16 v[36:37], v9 offset:6144
    ds_read_b64_tr_b16 v[38:39], v9 offset:6656
    v_mfma_f32_32x32x16_bf16 v[80:95], v[56:59], v[48:51], v[80:95]
    ds_read_b64_tr_b16 v[40:41], v9 offset:8192
    ds_read_b64_tr_b16 v[42:43], v9 offset:8704
    v_mfma_f32_32x32x16_bf16 v[96:111], v[48:51], v[60:63], v[96:111]
    ds_read_b64_tr_b16 v[44:45], v9 offset:10240
    ds_read_b64_tr_b16 v[46:47], v9 offset:10752
    s_waitcnt vmcnt(9)
    s_barrier
    s_waitcnt lgkmcnt(7)
    v_mfma_f32_32x32x16_bf16 v[64:79], v[20:23], v[16:19], v[64:79]
    ds_read_b128 v[48:51], v12 offset:20480
    ds_read_b64_tr_b16 v[52:53], v9 offset:12288
    ds_read_b64_tr_b16 v[54:55], v9 offset:12800
    s_add_u32 m0, s35, 24576
    s_add_u32 s37, s34, 0
    buffer_load_dwordx4 v7, s[24:27], s37 offen lds
    v_mfma_f32_32x32x16_bf16 v[80:95], v[24:27], v[16:19], v[80:95]
    ds_read_b64_tr_b16 v[56:57], v9 offset:14336
    ds_read_b64_tr_b16 v[58:59], v9 offset:14848
    s_add_u32 m0, s35, 26624
    s_add_u32 s37, s34, 1024
    buffer_load_dwordx4 v7, s[24:27], s37 offen lds
    v_mfma_f32_32x32x16_bf16 v[96:111], v[16:19], v[28:31], v[96:111]
    ds_read_b64_tr_b16 v[60:61], v9 offset:16384
    ds_read_b64_tr_b16 v[62:63], v9 offset:16896
    s_add_u32 m0, s35, 28672
    s_add_u32 s37, s34, 2048
    buffer_load_dwordx4 v7, s[24:27], s37 offen lds
    s_add_u32 s34, s34, 98304
    s_waitcnt lgkmcnt(7)
    v_mfma_f32_32x32x16_bf16 v[64:79], v[36:39], v[32:35], v[64:79]
    ds_read_b128 v[16:19], v13 offset:21504
    ds_read_b64_tr_b16 v[20:21], v9 offset:18432
    ds_read_b64_tr_b16 v[22:23], v9 offset:18944
    v_mfma_f32_32x32x16_bf16 v[80:95], v[40:43], v[32:35], v[80:95]
    ds_read_b64_tr_b16 v[24:25], v9 offset:20480
    ds_read_b64_tr_b16 v[26:27], v9 offset:20992
    v_mfma_f32_32x32x16_bf16 v[96:111], v[32:35], v[44:47], v[96:111]
    ds_read_b64_tr_b16 v[28:29], v9 offset:22528
    ds_read_b64_tr_b16 v[30:31], v9 offset:23040
    s_waitcnt vmcnt(9)
    s_barrier
    s_waitcnt lgkmcnt(7)
    v_mfma_f32_32x32x16_bf16 v[64:79], v[52:55], v[48:51], v[64:79]
    ds_read_b128 v[32:35], v14 offset:22528
    ds_read_b64_tr_b16 v[36:37], v9 offset:24576
    ds_read_b64_tr_b16 v[38:39], v9 offset:25088
    s_add_u32 m0, s35, 36864
    s_add_u32 s37, s34, 0
    buffer_load_dwordx4 v7, s[24:27], s37 offen lds
    v_mfma_f32_32x32x16_bf16 v[80:95], v[56:59], v[48:51], v[80:95]
    ds_read_b64_tr_b16 v[40:41], v9 offset:26624
    ds_read_b64_tr_b16 v[42:43], v9 offset:27136
    s_add_u32 m0, s35, 38912
    s_add_u32 s37, s34, 1024
    buffer_load_dwordx4 v7, s[24:27], s37 offen lds
    v_mfma_f32_32x32x16_bf16 v[96:111], v[48:51], v[60:63], v[96:111]
    ds_read_b64_tr_b16 v[44:45], v9 offset:28672
    ds_read_b64_tr_b16 v[46:47], v9 offset:29184
    s_add_u32 m0, s35, 40960
    s_add_u32 s37, s34, 2048
    buffer_load_dwordx4 v7, s[24:27], s37 offen lds
    s_add_u32 s34, s34, 98304
    s_waitcnt lgkmcnt(7)
    v_mfma_f32_32x32x16_bf16 v[64:79], v[20:23], v[16:19], v[64:79]
    ds_read_b128 v[48:51], v15 offset:23552
    ds_read_b64_tr_b16 v[52:53], v9 offset:30720
    ds_read_b64_tr_b16 v[54:55], v9 offset:31232
    v_mfma_f32_32x32x16_bf16 v[80:95], v[24:27], v[16:19], v[80:95]
    ds_read_b64_tr_b16 v[56:57], v9 offset:32768
    ds_read_b64_tr_b16 v[58:59], v9 offset:33280
    v_mfma_f32_32x32x16_bf16 v[96:111], v[16:19], v[28:31], v[96:111]
    ds_read_b64_tr_b16 v[60:61], v9 offset:34816
    ds_read_b64_tr_b16 v[62:63], v9 offset:35328
    s_waitcnt vmcnt(9)
    s_barrier
    s_waitcnt lgkmcnt(7)
    v_mfma_f32_32x32x16_bf16 v[64:79], v[36:39], v[32:35], v[64:79]
    ds_read_b128 v[16:19], v12 offset:24576
    ds_read_b64_tr_b16 v[20:21], v8 offset:0
    ds_read_b64_tr_b16 v[22:23], v8 offset:512
    v_mfma_f32_32x32x16_bf16 v[80:95], v[40:43], v[32:35], v[80:95]
    ds_read_b64_tr_b16 v[24:25], v8 offset:2048
    ds_read_b64_tr_b16 v[26:27], v8 offset:2560
    v_mfma_f32_32x32x16_bf16 v[96:111], v[32:35], v[44:47], v[96:111]
    ds_read_b64_tr_b16 v[28:29], v8 offset:4096
    ds_read_b64_tr_b16 v[30:31], v8 offset:4608
    v_lshrrev_b32 v148, 5, v1
    v_bfe_u32 v149, v1, 2, 2
    v_bfe_u32 v150, v1, 4, 1
    v_and_b32 v151, 3, v1
    v_bfe_u32 v152, v1, 3, 1
    v_lshlrev_b32 v144, 7, v149
    v_lshl_add_u32 v144, v151, 3, v144
    v_lshl_add_u32 v144, v150, 5, v144
    v_lshl_add_u32 v144, v152, 6, v144
    v_lshl_add_u32 v144, v148, 9, v144
    v_add_u32 v144, s56, v144
    v_xor_b32 v145, 64, v144
    v_add_u32 v146, 2048, v144
    v_add_u32 v147, 2048, v145
    s_cmp_ge_u32 s2, 224
    s_cbranch_scc1 JF_A1
    v_lshl_add_u32 v144, v150, 11, v144
    v_xor_b32 v145, 32, v144
    v_xor_b32 v146, 64, v144
    v_xor_b32 v147, 96, v144
JF_A1:
    ds_read_b64_tr_b16 v[128:129], v144
    ds_read_b64_tr_b16 v[130:131], v144 offset:1024
    ds_read_b64_tr_b16 v[132:133], v145
    ds_read_b64_tr_b16 v[134:135], v145 offset:1024
    ds_read_b64_tr_b16 v[136:137], v146
    ds_read_b64_tr_b16 v[138:139], v146 offset:1024
    ds_read_b64_tr_b16 v[140:141], v147
    ds_read_b64_tr_b16 v[142:143], v147 offset:1024
    s_waitcnt lgkmcnt(0)
    buffer_store_dwordx4 v[128:131], v2, s[12:15], s44 offen sc1
    buffer_store_dwordx4 v[132:135], v2, s[12:15], s45 offen sc1
    buffer_store_dwordx4 v[136:139], v2, s[12:15], s46 offen sc1
    buffer_store_dwordx4 v[140:143], v2, s[12:15], s47 offen sc1
    v_mfma_f32_32x32x16_bf16 v[64:79], v[52:55], v[48:51], v[64:79]
    ds_read_b128 v[32:35], v13 offset:25600
    ds_read_b64_tr_b16 v[36:37], v8 offset:6144
    ds_read_b64_tr_b16 v[38:39], v8 offset:6656
    v_mfma_f32_32x32x16_bf16 v[80:95], v[56:59], v[48:51], v[80:95]
    ds_read_b64_tr_b16 v[40:41], v8 offset:8192
    ds_read_b64_tr_b16 v[42:43], v8 offset:8704
    v_mfma_f32_32x32x16_bf16 v[96:111], v[48:51], v[60:63], v[96:111]
    ds_read_b64_tr_b16 v[44:45], v8 offset:10240
    ds_read_b64_tr_b16 v[46:47], v8 offset:10752
    s_waitcnt vmcnt(10)
    s_barrier
    v_mfma_f32_32x32x16_bf16 v[64:79], v[20:23], v[16:19], v[64:79]
    ds_read_b128 v[48:51], v14 offset:26624
    ds_read_b64_tr_b16 v[52:53], v8 offset:12288
    ds_read_b64_tr_b16 v[54:55], v8 offset:12800
    v_mfma_f32_32x32x16_bf16 v[80:95], v[24:27], v[16:19], v[80:95]
    ds_read_b64_tr_b16 v[56:57], v8 offset:14336
    ds_read_b64_tr_b16 v[58:59], v8 offset:14848
    v_mfma_f32_32x32x16_bf16 v[96:111], v[16:19], v[28:31], v[96:111]
    ds_read_b64_tr_b16 v[60:61], v8 offset:16384
    ds_read_b64_tr_b16 v[62:63], v8 offset:16896
    s_waitcnt lgkmcnt(7)
    v_mfma_f32_32x32x16_bf16 v[64:79], v[36:39], v[32:35], v[64:79]
    ds_read_b128 v[16:19], v15 offset:27648
    ds_read_b64_tr_b16 v[20:21], v8 offset:18432
    ds_read_b64_tr_b16 v[22:23], v8 offset:18944
    v_mfma_f32_32x32x16_bf16 v[80:95], v[40:43], v[32:35], v[80:95]
    ds_read_b64_tr_b16 v[24:25], v8 offset:20480
    ds_read_b64_tr_b16 v[26:27], v8 offset:20992
    v_mfma_f32_32x32x16_bf16 v[96:111], v[32:35], v[44:47], v[96:111]
    ds_read_b64_tr_b16 v[28:29], v8 offset:22528
    ds_read_b64_tr_b16 v[30:31], v8 offset:23040
    s_waitcnt vmcnt(7)
    s_barrier
    s_waitcnt lgkmcnt(7)
    v_mfma_f32_32x32x16_bf16 v[64:79], v[52:55], v[48:51], v[64:79]
    ds_read_b128 v[32:35], v12 offset:28672
    ds_read_b64_tr_b16 v[36:37], v8 offset:24576
    ds_read_b64_tr_b16 v[38:39], v8 offset:25088
    v_mfma_f32_32x32x16_bf16 v[80:95], v[56:59], v[48:51], v[80:95]
    ds_read_b64_tr_b16 v[40:41], v8 offset:26624
    ds_read_b64_tr_b16 v[42:43], v8 offset:27136
    v_mfma_f32_32x32x16_bf16 v[96:111], v[48:51], v[60:63], v[96:111]
    ds_read_b64_tr_b16 v[44:45], v8 offset:28672
    ds_read_b64_tr_b16 v[46:47], v8 offset:29184
    s_waitcnt lgkmcnt(7)
    v_mfma_f32_32x32x16_bf16 v[64:79], v[20:23], v[16:19], v[64:79]
    ds_read_b128 v[48:51], v13 offset:29696
    ds_read_b64_tr_b16 v[52:53], v8 offset:30720
    ds_read_b64_tr_b16 v[54:55], v8 offset:31232
    v_mfma_f32_32x32x16_bf16 v[80:95], v[24:27], v[16:19], v[80:95]
    ds_read_b64_tr_b16 v[56:57], v8 offset:32768
    ds_read_b64_tr_b16 v[58:59], v8 offset:33280
    v_mfma_f32_32x32x16_bf16 v[96:111], v[16:19], v[28:31], v[96:111]
    ds_read_b64_tr_b16 v[60:61], v8 offset:34816
    ds_read_b64_tr_b16 v[62:63], v8 offset:35328
    s_waitcnt vmcnt(4)
    s_barrier
    s_waitcnt lgkmcnt(7)
    v_mfma_f32_32x32x16_bf16 v[64:79], v[36:39], v[32:35], v[64:79]
    ds_read_b128 v[16:19], v14 offset:30720
    ds_read_b64_tr_b16 v[20:21], v9 offset:0
    ds_read_b64_tr_b16 v[22:23], v9 offset:512
    v_mfma_f32_32x32x16_bf16 v[80:95], v[40:43], v[32:35], v[80:95]
    ds_read_b64_tr_b16 v[24:25], v9 offset:2048
    ds_read_b64_tr_b16 v[26:27], v9 offset:2560
    v_mfma_f32_32x32x16_bf16 v[96:111], v[32:35], v[44:47], v[96:111]
    ds_read_b64_tr_b16 v[28:29], v9 offset:4096
    ds_read_b64_tr_b16 v[30:31], v9 offset:4608
    s_waitcnt lgkmcnt(7)
    v_mfma_f32_32x32x16_bf16 v[64:79], v[52:55], v[48:51], v[64:79]
    ds_read_b128 v[32:35], v15 offset:31744
    ds_read_b64_tr_b16 v[36:37], v9 offset:6144
    ds_read_b64_tr_b16 v[38:39], v9 offset:6656
    v_mfma_f32_32x32x16_bf16 v[80:95], v[56:59], v[48:51], v[80:95]
    ds_read_b64_tr_b16 v[40:41], v9 offset:8192
    ds_read_b64_tr_b16 v[42:43], v9 offset:8704
    v_mfma_f32_32x32x16_bf16 v[96:111], v[48:51], v[60:63], v[96:111]
    ds_read_b64_tr_b16 v[44:45], v9 offset:10240
    ds_read_b64_tr_b16 v[46:47], v9 offset:10752
    s_waitcnt lgkmcnt(7)
    v_mfma_f32_32x32x16_bf16 v[64:79], v[20:23], v[16:19], v[64:79]
    v_mfma_f32_32x32x16_bf16 v[80:95], v[24:27], v[16:19], v[80:95]
    v_mfma_f32_32x32x16_bf16 v[96:111], v[16:19], v[28:31], v[96:111]
    s_waitcnt lgkmcnt(0)
    v_mfma_f32_32x32x16_bf16 v[64:79], v[36:39], v[32:35], v[64:79]
    v_mfma_f32_32x32x16_bf16 v[80:95], v[40:43], v[32:35], v[80:95]
    v_mfma_f32_32x32x16_bf16 v[96:111], v[32:35], v[44:47], v[96:111]
    s_lshl_b32 s16, s5, 1
    s_lshr_b32 s17, s4, 1
    s_add_u32 s16, s16, s17
    s_lshl_b32 s17, s6, 1
    s_and_b32 s18, s4, 1
    s_add_u32 s17, s17, s18
    s_lshl_b32 s17, s17, 17
    s_lshl_b32 s18, s16, 10
    s_add_u32 s17, s17, s18
    s_add_u32 s19, s17, s18
    s_add_u32 s19, s19, 7340032
    s_mov_b32 s22, 1052289595
    s_nop 1
    s_and_b32 s30, s4, 1
    s_lshl_b32 s30, s30, 12
    s_lshr_b32 s31, s4, 1
    s_lshl_b32 s31, s31, 10
    s_add_u32 s30, s30, s31
    s_add_u32 s30, s30, 155648
    v_add_u32 v40, s30, v2
    v_cvt_pk_bf16_f32 v24, v80, v81
    v_cvt_pk_bf16_f32 v25, v82, v83
    v_cvt_pk_bf16_f32 v26, v84, v85
    v_cvt_pk_bf16_f32 v27, v86, v87
    s_add_u32 s20, s17, 5242880
    buffer_store_dwordx4 v[24:27], v2, s[12:15], s20 offen sc1
    v_cvt_pk_bf16_f32 v28, v88, v89
    v_cvt_pk_bf16_f32 v29, v90, v91
    v_cvt_pk_bf16_f32 v30, v92, v93
    v_cvt_pk_bf16_f32 v31, v94, v95
    s_add_u32 s20, s17, 5308416
    buffer_store_dwordx4 v[28:31], v2, s[12:15], s20 offen sc1
    v_cvt_pk_bf16_f32 v32, v96, v97
    v_cvt_pk_bf16_f32 v33, v98, v99
    v_cvt_pk_bf16_f32 v34, v100, v101
    v_cvt_pk_bf16_f32 v35, v102, v103
    buffer_store_dwordx4 v[32:35], v2, s[12:15], s19 offen offset:0 sc1
    v_cvt_pk_bf16_f32 v36, v104, v105
    v_cvt_pk_bf16_f32 v37, v106, v107
    v_cvt_pk_bf16_f32 v38, v108, v109
    v_cvt_pk_bf16_f32 v39, v110, v111
    buffer_store_dwordx4 v[36:39], v2, s[12:15], s19 offen offset:1024 sc1
    v_mul_f32 v64, s22, v64
    v_mul_f32 v65, s22, v65
    v_mul_f32 v66, s22, v66
    v_mul_f32 v67, s22, v67
    v_mul_f32 v68, s22, v68
    v_mul_f32 v69, s22, v69
    v_mul_f32 v70, s22, v70
    v_mul_f32 v71, s22, v71
    v_mul_f32 v72, s22, v72
    v_mul_f32 v73, s22, v73
    v_mul_f32 v74, s22, v74
    v_mul_f32 v75, s22, v75
    v_mul_f32 v76, s22, v76
    v_mul_f32 v77, s22, v77
    v_mul_f32 v78, s22, v78
    v_mul_f32 v79, s22, v79
    v_cvt_pk_bf16_f32 v16, v64, v65
    v_cvt_pk_bf16_f32 v17, v66, v67
    v_cvt_pk_bf16_f32 v18, v68, v69
    v_cvt_pk_bf16_f32 v19, v70, v71
    ds_write_b128 v40, v[16:19] offset:0
    v_cvt_pk_bf16_f32 v20, v72, v73
    v_cvt_pk_bf16_f32 v21, v74, v75
    v_cvt_pk_bf16_f32 v22, v76, v77
    v_cvt_pk_bf16_f32 v23, v78, v79
    ds_write_b128 v40, v[20:23] offset:2048
    v_mov_b32 v8, 0x3f803f80
    v_accvgpr_write_b32 a48, v8
    v_accvgpr_write_b32 a49, v8
    v_accvgpr_write_b32 a50, v8
    v_accvgpr_write_b32 a51, v8
    v_accvgpr_write_b32 a52, v8
    v_accvgpr_write_b32 a53, v8
    v_accvgpr_write_b32 a54, v8
    v_accvgpr_write_b32 a55, v8
    v_accvgpr_write_b32 a56, v8
    v_accvgpr_write_b32 a57, v8
    v_accvgpr_write_b32 a58, v8
    v_accvgpr_write_b32 a59, v8
    v_accvgpr_write_b32 a60, v8
    v_accvgpr_write_b32 a61, v8
    v_accvgpr_write_b32 a62, v8
    v_accvgpr_write_b32 a63, v8
    v_accvgpr_write_b32 a64, v8
    v_accvgpr_write_b32 a65, v8
    v_accvgpr_write_b32 a66, v8
    v_accvgpr_write_b32 a67, v8
    v_accvgpr_write_b32 a68, v8
    v_accvgpr_write_b32 a69, v8
    v_accvgpr_write_b32 a70, v8
    v_accvgpr_write_b32 a71, v8
    v_accvgpr_write_b32 a72, v8
    v_accvgpr_write_b32 a73, v8
    v_accvgpr_write_b32 a74, v8
    v_accvgpr_write_b32 a75, v8
    v_accvgpr_write_b32 a76, v8
    v_accvgpr_write_b32 a77, v8
    v_accvgpr_write_b32 a78, v8
    v_accvgpr_write_b32 a79, v8
    v_accvgpr_write_b32 a80, v8
    v_accvgpr_write_b32 a81, v8
    v_accvgpr_write_b32 a82, v8
    v_accvgpr_write_b32 a83, v8
    v_accvgpr_write_b32 a84, v8
    v_accvgpr_write_b32 a85, v8
    v_accvgpr_write_b32 a86, v8
    v_accvgpr_write_b32 a87, v8
    v_accvgpr_write_b32 a88, v8
    v_accvgpr_write_b32 a89, v8
    v_accvgpr_write_b32 a90, v8
    v_accvgpr_write_b32 a91, v8
    v_accvgpr_write_b32 a92, v8
    v_accvgpr_write_b32 a93, v8
    v_accvgpr_write_b32 a94, v8
    v_accvgpr_write_b32 a95, v8
    v_accvgpr_write_b32 a96, v8
    v_accvgpr_write_b32 a97, v8
    v_accvgpr_write_b32 a98, v8
    v_accvgpr_write_b32 a99, v8
    v_accvgpr_write_b32 a100, v8
    v_accvgpr_write_b32 a101, v8
    v_accvgpr_write_b32 a102, v8
    v_accvgpr_write_b32 a103, v8
    v_accvgpr_write_b32 a104, v8
    v_accvgpr_write_b32 a105, v8
    v_accvgpr_write_b32 a106, v8
    v_accvgpr_write_b32 a107, v8
    v_accvgpr_write_b32 a108, v8
    v_accvgpr_write_b32 a109, v8
    v_accvgpr_write_b32 a110, v8
    v_accvgpr_write_b32 a111, v8
    v_accvgpr_write_b32 a112, v8
    v_accvgpr_write_b32 a113, v8
    v_accvgpr_write_b32 a114, v8
    v_accvgpr_write_b32 a115, v8
    v_accvgpr_write_b32 a116, v8
    v_accvgpr_write_b32 a117, v8
    v_accvgpr_write_b32 a118, v8
    v_accvgpr_write_b32 a119, v8
    v_accvgpr_write_b32 a120, v8
    v_accvgpr_write_b32 a121, v8
    v_accvgpr_write_b32 a122, v8
    v_accvgpr_write_b32 a123, v8
    v_accvgpr_write_b32 a124, v8
    v_accvgpr_write_b32 a125, v8
    v_accvgpr_write_b32 a126, v8
    v_accvgpr_write_b32 a127, v8
    v_and_b32 v8, 31, v1
    v_lshrrev_b32 v9, 5, v1
    v_lshlrev_b32 v9, 2, v9
    v_sub_u32 v14, v8, v9
    v_mov_b32 v8, 0xffff
    v_mov_b32 v9, 0xffff0000
    v_cmp_le_i32 vcc, 0, v14
    v_cmp_le_i32 s[30:31], 1, v14
    s_nop 0
    v_cndmask_b32 v10, 0, v8, vcc
    v_cndmask_b32 v11, 0, v9, s[30:31]
    v_or_b32 v240, v10, v11
    v_cmp_le_i32 vcc, 2, v14
    v_cmp_le_i32 s[30:31], 3, v14
    s_nop 0
    v_cndmask_b32 v10, 0, v8, vcc
    v_cndmask_b32 v11, 0, v9, s[30:31]
    v_or_b32 v241, v10, v11
    v_cmp_le_i32 vcc, 8, v14
    v_cmp_le_i32 s[30:31], 9, v14
    s_nop 0
    v_cndmask_b32 v10, 0, v8, vcc
    v_cndmask_b32 v11, 0, v9, s[30:31]
    v_or_b32 v242, v10, v11
    v_cmp_le_i32 vcc, 10, v14
    v_cmp_le_i32 s[30:31], 11, v14
    s_nop 0
    v_cndmask_b32 v10, 0, v8, vcc
    v_cndmask_b32 v11, 0, v9, s[30:31]
    v_or_b32 v243, v10, v11
    v_cmp_le_i32 vcc, 16, v14
    v_cmp_le_i32 s[30:31], 17, v14
    s_nop 0
    v_cndmask_b32 v10, 0, v8, vcc
    v_cndmask_b32 v11, 0, v9, s[30:31]
    v_or_b32 v244, v10, v11
    v_cmp_le_i32 vcc, 18, v14
    v_cmp_le_i32 s[30:31], 19, v14
    s_nop 0
    v_cndmask_b32 v10, 0, v8, vcc
    v_cndmask_b32 v11, 0, v9, s[30:31]
    v_or_b32 v245, v10, v11
    v_cmp_le_i32 vcc, 24, v14
    v_cmp_le_i32 s[30:31], 25, v14
    s_nop 0
    v_cndmask_b32 v10, 0, v8, vcc
    v_cndmask_b32 v11, 0, v9, s[30:31]
    v_or_b32 v246, v10, v11
    v_cmp_le_i32 vcc, 26, v14
    v_cmp_le_i32 s[30:31], 27, v14
    s_nop 0
    v_cndmask_b32 v10, 0, v8, vcc
    v_cndmask_b32 v11, 0, v9, s[30:31]
    v_or_b32 v247, v10, v11
    s_lshl_b32 s19, s5, 1
    s_lshl_b32 s20, s6, 2
    s_add_u32 s20, s20, s4
    s_lshl_b32 s21, s20, 16
    s_lshl_b32 s22, s19, 10
    s_add_u32 s22, s22, s21
    s_add_u32 s22, s22, 3145728
    s_add_u32 s21, s21, 5242880
    s_lshr_b32 s23, s20, 1
    s_lshl_b32 s23, s23, 17
    s_and_b32 s24, s4, 1
    s_lshl_b32 s24, s24, 8
    s_add_u32 s23, s23, s24
    s_add_u32 s23, s23, 7340032
    v_min_u32 v8, 4, v1
    v_sub_u32 v8, s5, v8
    v_max_i32 v8, 0, v8
    v_lshlrev_b32 v8, 6, v8
    s_lshl_b32 s30, s6, 3
    v_add_u32 v8, s30, v8
    s_waitcnt lgkmcnt(0)
    s_waitcnt vmcnt(0)
    s_barrier
    s_cmp_lg_u32 s4, 0
    s_cbranch_scc1 PB4
    s_lshl_b32 s98, s7, 3
    s_add_u32 s98, s98, 591872
    v_mov_b32 v252, s96
    v_mov_b32 v253, s97
    v_mov_b32 v254, 0
    s_mov_b64 exec, 1
    buffer_store_dwordx2 v[252:253], v254, s[12:15], s98 offen sc1
    s_mov_b64 exec, -1
PB4:
    s_cmp_lg_u32 s4, 0
    s_cbranch_scc1 PB5
    s_lshl_b32 s98, s2, 3
    s_add_u32 s98, s98, 593920
    v_mov_b32 v252, s96
    v_mov_b32 v253, s97
    v_mov_b32 v254, 0
    s_mov_b64 exec, 1
    buffer_store_dwordx2 v[252:253], v254, s[12:15], s98 offen sc1
    s_mov_b64 exec, -1
PB5:
    s_lshl_b32 s30, s4, 11
    s_add_u32 s30, s30, 155648
    v_add_u32 v9, s30, v2
    ds_read_b128 a[0:3], v9
    ds_read_b128 a[4:7], v9 offset:1024
    s_cmp_lg_u32 s4, 0
    s_cbranch_scc1 PD6
    s_mov_b32 s99, 0
PL6:
    s_mov_b32 s98, 591872
    buffer_load_dwordx2 v[248:249], v8, s[12:15], s98 offen sc1
    s_add_u32 s99, s99, 1
    s_waitcnt vmcnt(0)
    v_cmp_ne_u64 vcc, s[96:97], v[248:249]
    s_cmp_eq_u64 vcc, 0
    s_cbranch_scc1 PD6
    s_sleep 2
    s_cmp_lt_u32 s99, 50000
    s_cbranch_scc1 PL6
PD6:
    s_waitcnt vmcnt(0)
    s_barrier
    s_waitcnt lgkmcnt(0)
    s_add_i32 s28, s19, -8
    s_max_i32 s28, s28, 0
    s_lshl_b32 s29, s28, 10
    s_add_u32 s30, s29, s21
    buffer_load_dwordx4 a[8:11], v2, s[12:15], s30 offen offset:0 sc1
    buffer_load_dwordx4 a[12:15], v2, s[12:15], s30 offen offset:1024 sc1
    s_add_i32 s28, s19, -6
    s_max_i32 s28, s28, 0
    s_lshl_b32 s29, s28, 10
    s_add_u32 s30, s29, s21
    buffer_load_dwordx4 a[16:19], v2, s[12:15], s30 offen offset:0 sc1
    buffer_load_dwordx4 a[20:23], v2, s[12:15], s30 offen offset:1024 sc1
    s_add_i32 s28, s19, -4
    s_max_i32 s28, s28, 0
    s_lshl_b32 s29, s28, 10
    s_add_u32 s30, s29, s21
    buffer_load_dwordx4 a[24:27], v2, s[12:15], s30 offen offset:0 sc1
    buffer_load_dwordx4 a[28:31], v2, s[12:15], s30 offen offset:1024 sc1
    s_add_i32 s28, s19, -2
    s_max_i32 s28, s28, 0
    s_lshl_b32 s29, s28, 10
    s_add_u32 s30, s29, s21
    buffer_load_dwordx4 a[32:35], v2, s[12:15], s30 offen offset:0 sc1
    buffer_load_dwordx4 a[36:39], v2, s[12:15], s30 offen offset:1024 sc1
    s_add_i32 s28, s19, 0
    s_max_i32 s28, s28, 0
    s_lshl_b32 s29, s28, 10
    s_add_u32 s30, s29, s21
    buffer_load_dwordx4 a[40:43], v2, s[12:15], s30 offen offset:0 sc1
    buffer_load_dwordx4 a[44:47], v2, s[12:15], s30 offen offset:1024 sc1
    s_mov_b32 s26, 0xffff
    s_mov_b32 s27, 0xffff
    s_add_i32 s28, s19, -8
    s_max_i32 s28, s28, 0
    s_lshl_b32 s29, s28, 11
    s_add_u32 s30, s29, s23
    s_mov_b64 exec, s[26:27]
    buffer_load_dwordx4 a[48:51], v2, s[12:15], s30 offen offset:0 sc1
    s_mov_b64 exec, -1
    s_mov_b64 exec, s[26:27]
    buffer_load_dwordx4 a[52:55], v2, s[12:15], s30 offen offset:1024 sc1
    s_mov_b64 exec, -1
    s_mov_b64 exec, s[26:27]
    buffer_load_dwordx4 a[56:59], v2, s[12:15], s30 offen offset:2048 sc1
    s_mov_b64 exec, -1
    s_mov_b64 exec, s[26:27]
    buffer_load_dwordx4 a[60:63], v2, s[12:15], s30 offen offset:3072 sc1
    s_mov_b64 exec, -1
    s_add_i32 s28, s19, -6
    s_max_i32 s28, s28, 0
    s_lshl_b32 s29, s28, 11
    s_add_u32 s30, s29, s23
    s_mov_b64 exec, s[26:27]
    buffer_load_dwordx4 a[64:67], v2, s[12:15], s30 offen offset:0 sc1
    s_mov_b64 exec, -1
    s_mov_b64 exec, s[26:27]
    buffer_load_dwordx4 a[68:71], v2, s[12:15], s30 offen offset:1024 sc1
    s_mov_b64 exec, -1
    s_mov_b64 exec, s[26:27]
    buffer_load_dwordx4 a[72:75], v2, s[12:15], s30 offen offset:2048 sc1
    s_mov_b64 exec, -1
    s_mov_b64 exec, s[26:27]
    buffer_load_dwordx4 a[76:79], v2, s[12:15], s30 offen offset:3072 sc1
    s_mov_b64 exec, -1
    s_and_b32 s40, s5, 1
    s_lshl_b32 s40, s40, 3
    s_add_u32 s40, s40, s6
    s_mul_i32 s31, s40, 7
    s_lshr_b32 s31, s31, 2
    s_lshl_b32 s31, s31, 3
    s_sub_u32 s31, s31, 32
    v_min_u32 v15, 55, v1
    v_add_u32 v15, s31, v15
    v_add_u32 v13, 224, v1
    v_cmp_gt_u32 vcc, 32, v1
    s_nop 1
    v_cndmask_b32 v15, v15, v13, vcc
    v_lshlrev_b32 v15, 3, v15
    s_lshl_b32 s25, s19, 15
    s_lshl_b32 s21, s20, 10
    s_add_u32 s25, s25, s21
    s_add_u32 s25, s25, 9437184
    s_waitcnt vmcnt(8)
    v_mfma_f32_32x32x16_bf16 v[192:207], a[40:43], a[0:3], 0
    s_cmp_lt_u32 s19, 8
    s_cbranch_scc1 P2F00
    v_mfma_f32_32x32x16_bf16 v[64:79], a[8:11], a[0:3], 0
P2N00:
    s_cmp_lt_u32 s19, 7
    s_cbranch_scc1 P2F01
    v_mfma_f32_32x32x16_bf16 v[80:95], a[12:15], a[0:3], 0
P2N01:
    s_cmp_lt_u32 s19, 6
    s_cbranch_scc1 P2F02
    v_mfma_f32_32x32x16_bf16 v[96:111], a[16:19], a[0:3], 0
P2N02:
    s_cmp_lt_u32 s19, 5
    s_cbranch_scc1 P2F03
    v_mfma_f32_32x32x16_bf16 v[112:127], a[20:23], a[0:3], 0
P2N03:
    s_cmp_lt_u32 s19, 4
    s_cbranch_scc1 P2F04
    v_mfma_f32_32x32x16_bf16 v[128:143], a[24:27], a[0:3], 0
P2N04:
    s_cmp_lt_u32 s19, 3
    s_cbranch_scc1 P2F05
    v_mfma_f32_32x32x16_bf16 v[144:159], a[28:31], a[0:3], 0
P2N05:
    s_cmp_lt_u32 s19, 2
    s_cbranch_scc1 P2F06
    v_mfma_f32_32x32x16_bf16 v[160:175], a[32:35], a[0:3], 0
P2N06:
    s_cmp_lt_u32 s19, 1
    s_cbranch_scc1 P2F07
    v_mfma_f32_32x32x16_bf16 v[176:191], a[36:39], a[0:3], 0
P2N07:
    v_cmp_le_i32 s[32:33], 0, v14
    v_cmp_le_i32 s[34:35], 1, v14
    v_cmp_le_i32 s[36:37], 2, v14
    v_cmp_le_i32 s[38:39], 3, v14
    v_cndmask_b32 v64, v64, v192, s[32:33]
    v_cndmask_b32 v65, v65, v193, s[34:35]
    v_cndmask_b32 v66, v66, v194, s[36:37]
    v_cndmask_b32 v67, v67, v195, s[38:39]
    v_cmp_le_i32 s[32:33], 8, v14
    v_cmp_le_i32 s[34:35], 9, v14
    v_cmp_le_i32 s[36:37], 10, v14
    v_cmp_le_i32 s[38:39], 11, v14
    v_cndmask_b32 v68, v68, v196, s[32:33]
    v_cndmask_b32 v69, v69, v197, s[34:35]
    v_cndmask_b32 v70, v70, v198, s[36:37]
    v_cndmask_b32 v71, v71, v199, s[38:39]
    v_cmp_le_i32 s[32:33], 16, v14
    v_cmp_le_i32 s[34:35], 17, v14
    v_cmp_le_i32 s[36:37], 18, v14
    v_cmp_le_i32 s[38:39], 19, v14
    v_cndmask_b32 v72, v72, v200, s[32:33]
    v_cndmask_b32 v73, v73, v201, s[34:35]
    v_cndmask_b32 v74, v74, v202, s[36:37]
    v_cndmask_b32 v75, v75, v203, s[38:39]
    v_cmp_le_i32 s[32:33], 24, v14
    v_cmp_le_i32 s[34:35], 25, v14
    v_cmp_le_i32 s[36:37], 26, v14
    v_cmp_le_i32 s[38:39], 27, v14
    v_cndmask_b32 v76, v76, v204, s[32:33]
    v_cndmask_b32 v77, v77, v205, s[34:35]
    v_cndmask_b32 v78, v78, v206, s[36:37]
    v_cndmask_b32 v79, v79, v207, s[38:39]
    v_max3_f32 v8, v64, v65, v66
    v_max3_f32 v9, v67, v68, v69
    v_max3_f32 v8, v8, v70, v71
    v_max3_f32 v9, v9, v72, v73
    s_add_i32 s28, s19, -4
    s_max_i32 s28, s28, 0
    s_lshl_b32 s29, s28, 11
    s_add_u32 s30, s29, s23
    s_mov_b64 exec, s[26:27]
    buffer_load_dwordx4 a[80:83], v2, s[12:15], s30 offen offset:0 sc1
    s_mov_b64 exec, -1
    v_max3_f32 v8, v8, v74, v75
    v_max3_f32 v9, v9, v76, v77
    v_max3_f32 v8, v8, v78, v79
    v_max3_f32 v9, v9, v80, v81
    s_mov_b64 exec, s[26:27]
    buffer_load_dwordx4 a[84:87], v2, s[12:15], s30 offen offset:1024 sc1
    s_mov_b64 exec, -1
    v_max3_f32 v8, v8, v82, v83
    v_max3_f32 v9, v9, v84, v85
    v_max3_f32 v8, v8, v86, v87
    v_max3_f32 v9, v9, v88, v89
    s_mov_b64 exec, s[26:27]
    buffer_load_dwordx4 a[88:91], v2, s[12:15], s30 offen offset:2048 sc1
    s_mov_b64 exec, -1
    v_max3_f32 v8, v8, v90, v91
    v_max3_f32 v9, v9, v92, v93
    v_max3_f32 v8, v8, v94, v95
    v_max3_f32 v9, v9, v96, v97
    s_mov_b64 exec, s[26:27]
    buffer_load_dwordx4 a[92:95], v2, s[12:15], s30 offen offset:3072 sc1
    s_mov_b64 exec, -1
    v_max3_f32 v8, v8, v98, v99
    v_max3_f32 v9, v9, v100, v101
    v_max3_f32 v8, v8, v102, v103
    v_max3_f32 v9, v9, v104, v105
    s_add_i32 s28, s19, -2
    s_max_i32 s28, s28, 0
    s_lshl_b32 s29, s28, 11
    s_add_u32 s30, s29, s23
    s_mov_b64 exec, s[26:27]
    buffer_load_dwordx4 a[96:99], v2, s[12:15], s30 offen offset:0 sc1
    s_mov_b64 exec, -1
    v_max3_f32 v8, v8, v106, v107
    v_max3_f32 v9, v9, v108, v109
    v_max3_f32 v8, v8, v110, v111
    v_max3_f32 v9, v9, v112, v113
    s_mov_b64 exec, s[26:27]
    buffer_load_dwordx4 a[100:103], v2, s[12:15], s30 offen offset:1024 sc1
    s_mov_b64 exec, -1
    v_max3_f32 v8, v8, v114, v115
    v_max3_f32 v9, v9, v116, v117
    v_max3_f32 v8, v8, v118, v119
    v_max3_f32 v9, v9, v120, v121
    s_mov_b64 exec, s[26:27]
    buffer_load_dwordx4 a[104:107], v2, s[12:15], s30 offen offset:2048 sc1
    s_mov_b64 exec, -1
    v_max3_f32 v8, v8, v122, v123
    v_max3_f32 v9, v9, v124, v125
    v_max3_f32 v8, v8, v126, v127
    v_max3_f32 v9, v9, v128, v129
    s_mov_b64 exec, s[26:27]
    buffer_load_dwordx4 a[108:111], v2, s[12:15], s30 offen offset:3072 sc1
    s_mov_b64 exec, -1
    v_max3_f32 v8, v8, v130, v131
    v_max3_f32 v9, v9, v132, v133
    v_max3_f32 v8, v8, v134, v135
    v_max3_f32 v9, v9, v136, v137
    s_add_i32 s28, s19, 0
    s_max_i32 s28, s28, 0
    s_lshl_b32 s29, s28, 11
    s_add_u32 s30, s29, s23
    s_mov_b64 exec, s[26:27]
    buffer_load_dwordx4 a[112:115], v2, s[12:15], s30 offen offset:0 sc1
    s_mov_b64 exec, -1
    v_max3_f32 v8, v8, v138, v139
    v_max3_f32 v9, v9, v140, v141
    v_max3_f32 v8, v8, v142, v143
    v_max3_f32 v9, v9, v144, v145
    s_mov_b64 exec, s[26:27]
    buffer_load_dwordx4 a[116:119], v2, s[12:15], s30 offen offset:1024 sc1
    s_mov_b64 exec, -1
    v_max3_f32 v8, v8, v146, v147
    v_max3_f32 v9, v9, v148, v149
    v_max3_f32 v8, v8, v150, v151
    v_max3_f32 v9, v9, v152, v153
    s_mov_b64 exec, s[26:27]
    buffer_load_dwordx4 a[120:123], v2, s[12:15], s30 offen offset:2048 sc1
    s_mov_b64 exec, -1
    v_max3_f32 v8, v8, v154, v155
    v_max3_f32 v9, v9, v156, v157
    v_max3_f32 v8, v8, v158, v159
    v_max3_f32 v9, v9, v160, v161
    s_mov_b64 exec, s[26:27]
    buffer_load_dwordx4 a[124:127], v2, s[12:15], s30 offen offset:3072 sc1
    s_mov_b64 exec, -1
    v_max3_f32 v8, v8, v162, v163
    v_max3_f32 v9, v9, v164, v165
    v_max3_f32 v8, v8, v166, v167
    v_max3_f32 v9, v9, v168, v169
    v_max3_f32 v8, v8, v170, v171
    v_max3_f32 v9, v9, v172, v173
    v_max3_f32 v8, v8, v174, v175
    v_max3_f32 v9, v9, v176, v177
    v_max3_f32 v8, v8, v178, v179
    v_max3_f32 v9, v9, v180, v181
    v_max3_f32 v8, v8, v182, v183
    v_max3_f32 v9, v9, v184, v185
    v_max3_f32 v8, v8, v186, v187
    v_max3_f32 v9, v9, v188, v189
    s_mov_b32 s98, 593920
    buffer_load_dwordx2 v[16:17], v15, s[12:15], s98 offen sc1
    v_max3_f32 v8, v8, v190, v191
    v_max_f32 v8, v8, v9
    v_mov_b32 v9, v8
    s_nop 1
    v_permlane32_swap_b32 v8, v9
    v_max_f32 v8, v8, v9
    v_sub_f32 v224, 0, v8
    v_sub_f32 v225, 0, v8
    v_sub_f32 v226, 0, v8
    v_sub_f32 v227, 0, v8
    v_sub_f32 v228, 0, v8
    v_sub_f32 v229, 0, v8
    v_sub_f32 v230, 0, v8
    v_sub_f32 v231, 0, v8
    v_sub_f32 v232, 0, v8
    v_sub_f32 v233, 0, v8
    v_sub_f32 v234, 0, v8
    v_sub_f32 v235, 0, v8
    v_sub_f32 v236, 0, v8
    v_sub_f32 v237, 0, v8
    v_sub_f32 v238, 0, v8
    v_sub_f32 v239, 0, v8
    s_cmp_lt_u32 s19, 7
    s_cbranch_scc1 P2S01
    v_mfma_f32_32x32x16_bf16 v[80:95], a[12:15], a[0:3], v[224:239]
P2S01:
    v_sub_f32 v64, v64, v8
    v_sub_f32 v65, v65, v8
    v_sub_f32 v66, v66, v8
    v_sub_f32 v67, v67, v8
    v_sub_f32 v68, v68, v8
    v_sub_f32 v69, v69, v8
    v_sub_f32 v70, v70, v8
    v_sub_f32 v71, v71, v8
    v_sub_f32 v72, v72, v8
    v_sub_f32 v73, v73, v8
    v_sub_f32 v74, v74, v8
    v_sub_f32 v75, v75, v8
    v_sub_f32 v76, v76, v8
    v_sub_f32 v77, v77, v8
    v_sub_f32 v78, v78, v8
    v_sub_f32 v79, v79, v8
    v_exp_f32 v64, v64
    v_exp_f32 v65, v65
    v_exp_f32 v66, v66
    v_exp_f32 v67, v67
    v_exp_f32 v68, v68
    v_exp_f32 v69, v69
    s_cmp_lt_u32 s19, 6
    s_cbranch_scc1 P2S02
    v_mfma_f32_32x32x16_bf16 v[96:111], a[16:19], a[0:3], v[224:239]
P2S02:
    v_exp_f32 v70, v70
    v_exp_f32 v71, v71
    s_nop 0
    v_cvt_pk_bf16_f32 v64, v64, v65
    v_cvt_pk_bf16_f32 v65, v66, v67
    v_cvt_pk_bf16_f32 v66, v68, v69
    v_cvt_pk_bf16_f32 v67, v70, v71
    v_exp_f32 v72, v72
    v_exp_f32 v73, v73
    v_exp_f32 v74, v74
    v_exp_f32 v75, v75
    v_exp_f32 v76, v76
    v_exp_f32 v77, v77
    v_exp_f32 v78, v78
    v_exp_f32 v79, v79
    s_nop 0
    v_cvt_pk_bf16_f32 v68, v72, v73
    v_cvt_pk_bf16_f32 v69, v74, v75
    v_cvt_pk_bf16_f32 v70, v76, v77
    v_cvt_pk_bf16_f32 v71, v78, v79
    v_and_b32 v72, v240, v64
    v_xor_b32 v64, v72, v64
    v_and_b32 v73, v241, v65
    v_xor_b32 v65, v73, v65
    v_and_b32 v74, v242, v66
    v_xor_b32 v66, v74, v66
    v_and_b32 v75, v243, v67
    v_xor_b32 v67, v75, v67
    v_and_b32 v76, v244, v68
    v_xor_b32 v68, v76, v68
    v_and_b32 v77, v245, v69
    v_xor_b32 v69, v77, v69
    v_and_b32 v78, v246, v70
    v_xor_b32 v70, v78, v70
    v_and_b32 v79, v247, v71
    v_xor_b32 v71, v79, v71
    s_waitcnt vmcnt(0)
    v_cmp_ne_u64 vcc, s[96:97], v[16:17]
    s_cmp_eq_u64 vcc, 0
    s_cbranch_scc1 FAOK
    s_mov_b32 s99, 0
PL7:
    s_mov_b32 s98, 593920
    buffer_load_dwordx2 v[16:17], v15, s[12:15], s98 offen sc1
    s_add_u32 s99, s99, 1
    s_waitcnt vmcnt(0)
    v_cmp_ne_u64 vcc, s[96:97], v[16:17]
    s_cmp_eq_u64 vcc, 0
    s_cbranch_scc1 PD7
    s_sleep 2
    s_cmp_lt_u32 s99, 50000
    s_cbranch_scc1 PL7
PD7:
FAOK:
    v_lshrrev_b32 v60, 3, v1
    v_and_b32 v61, 7, v1
    v_lshlrev_b32 v61, 4, v61
    v_and_b32 v59, 16, v1
    v_lshlrev_b32 v59, 2, v59
    v_xor_b32 v61, v61, v59
    s_lshl_b32 s56, s4, 12
    s_add_u32 s56, s56, 139264
    s_cmp_ge_u32 s2, 112
    s_cbranch_scc1 JI_B2
    s_load_dwordx2 s[48:49], s[0:1], 48
    s_mov_b32 s50, 1835008
    s_mov_b32 s51, 0x00020000
    s_sub_u32 s57, s2, 0
    s_and_b32 s58, s57, 7
    s_lshr_b32 s57, s57, 3
    s_lshl_b32 s57, s57, 3
    s_lshl_b32 s59, s4, 1
    s_add_u32 s57, s57, s59
    s_mul_i32 s44, s58, 229376
    s_lshl_b32 s59, s57, 10
    s_add_u32 s44, s44, s59
    s_add_u32 s44, s44, 29884416
    s_add_u32 s45, s44, 114688
    s_add_u32 s46, s44, 1024
    s_add_u32 s47, s45, 1024
    s_lshl_b32 s59, s57, 14
    s_lshl_b32 s60, s58, 7
    s_add_u32 s59, s59, s60
    v_lshl_add_u32 v60, v60, 10, v61
    s_waitcnt lgkmcnt(0)
    s_add_u32 m0, s56, 0
    s_nop 0
    buffer_load_dwordx4 v60, s[48:51], s59 offen lds
    s_add_u32 s59, s59, 8192
    s_add_u32 m0, s56, 1024
    s_nop 0
    buffer_load_dwordx4 v60, s[48:51], s59 offen lds
    s_add_u32 s59, s59, 8192
    s_add_u32 m0, s56, 2048
    s_nop 0
    buffer_load_dwordx4 v60, s[48:51], s59 offen lds
    s_add_u32 s59, s59, 8192
    s_add_u32 m0, s56, 3072
    s_nop 0
    buffer_load_dwordx4 v60, s[48:51], s59 offen lds
    s_add_u32 s59, s59, 8192
JI_B2:
    s_mov_b32 s57, 0x7f000000
    s_cmp_lt_u32 s2, 112
    s_cbranch_scc1 BI4
    s_cmp_ge_u32 s2, 224
    s_cbranch_scc1 BI4
    s_sub_u32 s44, s2, 112
    s_load_dwordx2 s[48:49], s[0:1], 32
    s_load_dwordx2 s[52:53], s[0:1], 40
    s_mov_b32 s50, 1835008
    s_mov_b32 s51, 0x00020000
    s_mov_b32 s54, 1835008
    s_mov_b32 s55, 0x00020000
    v_lshrrev_b32 v12, 2, v1
    v_and_b32 v13, 3, v1
    v_mul_u32_u24 v12, 3584, v12
    v_lshl_add_u32 v12, v13, 4, v12
    s_waitcnt lgkmcnt(0)
    s_cmp_ge_u32 s44, 56
    s_cselect_b32 s48, s52, s48
    s_cselect_b32 s49, s53, s49
    s_cselect_b32 s58, 56, 0
    s_cselect_b32 s45, 1024, 0
    s_sub_u32 s44, s44, s58
    s_mul_i32 s58, s4, 458752
    s_lshl_b32 s59, s44, 6
    s_add_u32 s58, s58, s59
    buffer_load_dwordx4 v[32:35], v12, s[48:51], s58 offen
    s_add_u32 s58, s58, 57344
    buffer_load_dwordx4 v[36:39], v12, s[48:51], s58 offen
    s_add_u32 s58, s58, 57344
    buffer_load_dwordx4 v[40:43], v12, s[48:51], s58 offen
    s_add_u32 s58, s58, 57344
    buffer_load_dwordx4 v[44:47], v12, s[48:51], s58 offen
    s_add_u32 s58, s58, 57344
    buffer_load_dwordx4 v[48:51], v12, s[48:51], s58 offen
    s_add_u32 s58, s58, 57344
    buffer_load_dwordx4 v[52:55], v12, s[48:51], s58 offen
    s_add_u32 s58, s58, 57344
    buffer_load_dwordx4 v[56:59], v12, s[48:51], s58 offen
    s_add_u32 s58, s58, 57344
    buffer_load_dwordx4 v[60:63], v12, s[48:51], s58 offen
    s_add_u32 s58, s58, 57344
BI4:
    s_mov_b32 s3, s5
    s_mov_b32 s63, s6
    s_mul_i32 s16, s3, 65536
    s_mul_i32 s20, s4, 8192
    s_add_u32 s16, s16, s20
    s_add_u32 s16, s16, 9437184
    s_add_u32 s17, s16, 32768
    s_mul_i32 s26, s63, 65536
    s_add_u32 s26, s26, s20
    s_add_u32 s26, s26, 25690112
    s_add_u32 s27, s26, 32768
    s_bitcmp1_b32 s4, 1
    s_cselect_b32 s20, s16, s17
    s_cselect_b32 s17, s17, s16
    s_mov_b32 s16, s20
    s_bitcmp1_b32 s4, 0
    s_cselect_b32 s20, s26, s27
    s_cselect_b32 s27, s27, s26
    s_mov_b32 s26, s20
    s_xor_b32 s20, s4, 3
    s_mul_i32 s20, s20, 12288
    s_add_u32 s20, s20, 114688
    v_add_u32 v4, s20, v2
    s_xor_b32 s20, s4, 2
    s_mul_i32 s20, s20, 12288
    s_add_u32 s20, s20, 114688
    v_add_u32 v5, s20, v2
    s_xor_b32 s20, s4, 1
    s_mul_i32 s20, s20, 12288
    s_add_u32 s20, s20, 114688
    v_add_u32 v6, s20, v2
    s_xor_b32 s20, s4, 0
    s_mul_i32 s20, s20, 12288
    s_add_u32 s20, s20, 114688
    v_add_u32 v7, s20, v2
    s_lshr_b32 s22, s4, 1
    s_lshl_b32 s21, s3, 1
    s_add_u32 s22, s22, s21
    s_and_b32 s23, s4, 1
    s_lshl_b32 s21, s63, 1
    s_add_u32 s23, s23, s21
    v_and_b32 v10, 31, v1
    v_lshrrev_b32 v11, 5, v1
    v_lshlrev_b32 v10, 10, v10
    v_lshl_add_u32 v10, v11, 4, v10
    v_lshlrev_b32 v11, 4, v11
    s_and_b32 s40, s5, 1
    s_lshl_b32 s40, s40, 3
    s_add_u32 s40, s40, s6
    s_mul_i32 s41, s40, 229376
    s_add_u32 s41, s41, 26214400
    s_lshl_b32 s43, s4, 12
    s_add_u32 s42, s41, s43
    s_lshl_b32 s28, s22, 15
    s_lshl_b32 s29, s23, 6
    s_add_u32 s28, s28, s29
    s_lshl_b32 s29, s23, 7
    s_add_u32 s30, s29, 4096
    s_add_u32 s31, s29, 8192
    v_and_b32 v15, 0x3c, v1
    s_lshl_b32 s57, s4, 9
    s_add_u32 s57, s57, 6144
    s_cmp_lt_u32 s2, 112
    s_cbranch_scc1 PF9
    s_cmp_ge_u32 s2, 224
    s_cbranch_scc1 PF9
    buffer_load_dword a232, v15, s[12:15], s57 offen offset:0 sc1
    buffer_load_dword a240, v15, s[12:15], s57 offen offset:2048 sc1
    buffer_load_dword a233, v15, s[12:15], s57 offen offset:64 sc1
    buffer_load_dword a241, v15, s[12:15], s57 offen offset:2112 sc1
    buffer_load_dword a234, v15, s[12:15], s57 offen offset:128 sc1
    buffer_load_dword a242, v15, s[12:15], s57 offen offset:2176 sc1
    buffer_load_dword a235, v15, s[12:15], s57 offen offset:192 sc1
    buffer_load_dword a243, v15, s[12:15], s57 offen offset:2240 sc1
    buffer_load_dword a236, v15, s[12:15], s57 offen offset:256 sc1
    buffer_load_dword a244, v15, s[12:15], s57 offen offset:2304 sc1
    buffer_load_dword a237, v15, s[12:15], s57 offen offset:320 sc1
    buffer_load_dword a245, v15, s[12:15], s57 offen offset:2368 sc1
    buffer_load_dword a238, v15, s[12:15], s57 offen offset:384 sc1
    buffer_load_dword a246, v15, s[12:15], s57 offen offset:2432 sc1
    buffer_load_dword a239, v15, s[12:15], s57 offen offset:448 sc1
    buffer_load_dword a247, v15, s[12:15], s57 offen offset:2496 sc1
PF9:
    v_exp_f32 v80, v80
    v_exp_f32 v81, v81
    v_mfma_f32_32x32x16_bf16 v[208:223], a[48:51], v[64:67], 0
    v_exp_f32 v82, v82
    v_exp_f32 v83, v83
    v_exp_f32 v84, v84
    v_exp_f32 v85, v85
    s_cmp_lt_u32 s19, 5
    s_cbranch_scc1 P2S03
    v_mfma_f32_32x32x16_bf16 v[112:127], a[20:23], a[0:3], v[224:239]
P2S03:
    v_exp_f32 v86, v86
    v_exp_f32 v87, v87
    s_nop 0
    v_cvt_pk_bf16_f32 v80, v80, v81
    v_cvt_pk_bf16_f32 v81, v82, v83
    v_cvt_pk_bf16_f32 v82, v84, v85
    v_cvt_pk_bf16_f32 v83, v86, v87
    v_exp_f32 v88, v88
    v_exp_f32 v89, v89
    v_mfma_f32_32x32x16_bf16 v[208:223], a[52:55], v[68:71], v[208:223]
    v_exp_f32 v90, v90
    v_exp_f32 v91, v91
    v_exp_f32 v92, v92
    v_exp_f32 v93, v93
    v_mfma_f32_32x32x16_bf16 v[208:223], a[112:115], v[72:75], v[208:223]
    v_exp_f32 v94, v94
    v_exp_f32 v95, v95
    s_nop 0
    v_cvt_pk_bf16_f32 v84, v88, v89
    v_cvt_pk_bf16_f32 v85, v90, v91
    v_cvt_pk_bf16_f32 v86, v92, v93
    v_cvt_pk_bf16_f32 v87, v94, v95
    v_exp_f32 v96, v96
    v_exp_f32 v97, v97
    v_mfma_f32_32x32x16_bf16 v[208:223], a[116:119], v[76:79], v[208:223]
    v_exp_f32 v98, v98
    v_exp_f32 v99, v99
    v_exp_f32 v100, v100
    v_exp_f32 v101, v101
    s_cmp_lt_u32 s19, 4
    s_cbranch_scc1 P2S04
    v_mfma_f32_32x32x16_bf16 v[128:143], a[24:27], a[0:3], v[224:239]
P2S04:
    v_exp_f32 v102, v102
    v_exp_f32 v103, v103
    s_nop 0
    v_cvt_pk_bf16_f32 v96, v96, v97
    v_cvt_pk_bf16_f32 v97, v98, v99
    v_cvt_pk_bf16_f32 v98, v100, v101
    v_cvt_pk_bf16_f32 v99, v102, v103
    v_exp_f32 v104, v104
    v_exp_f32 v105, v105
    v_mfma_f32_32x32x16_bf16 v[208:223], a[56:59], v[80:83], v[208:223]
    v_exp_f32 v106, v106
    v_exp_f32 v107, v107
    v_exp_f32 v108, v108
    v_exp_f32 v109, v109
    v_mfma_f32_32x32x16_bf16 v[208:223], a[60:63], v[84:87], v[208:223]
    v_exp_f32 v110, v110
    v_exp_f32 v111, v111
    s_nop 0
    v_cvt_pk_bf16_f32 v100, v104, v105
    v_cvt_pk_bf16_f32 v101, v106, v107
    v_cvt_pk_bf16_f32 v102, v108, v109
    v_cvt_pk_bf16_f32 v103, v110, v111
    v_exp_f32 v112, v112
    v_exp_f32 v113, v113
    v_mfma_f32_32x32x16_bf16 v[208:223], a[64:67], v[96:99], v[208:223]
    v_exp_f32 v114, v114
    v_exp_f32 v115, v115
    v_exp_f32 v116, v116
    v_exp_f32 v117, v117
    s_cmp_lt_u32 s19, 3
    s_cbranch_scc1 P2S05
    v_mfma_f32_32x32x16_bf16 v[144:159], a[28:31], a[0:3], v[224:239]
P2S05:
    v_exp_f32 v118, v118
    v_exp_f32 v119, v119
    s_nop 0
    v_cvt_pk_bf16_f32 v112, v112, v113
    v_cvt_pk_bf16_f32 v113, v114, v115
    v_cvt_pk_bf16_f32 v114, v116, v117
    v_cvt_pk_bf16_f32 v115, v118, v119
    v_exp_f32 v120, v120
    v_exp_f32 v121, v121
    v_mfma_f32_32x32x16_bf16 v[208:223], a[68:71], v[100:103], v[208:223]
    v_exp_f32 v122, v122
    v_exp_f32 v123, v123
    v_exp_f32 v124, v124
    v_exp_f32 v125, v125
    v_exp_f32 v126, v126
    v_exp_f32 v127, v127
    s_nop 0
    v_cvt_pk_bf16_f32 v116, v120, v121
    v_cvt_pk_bf16_f32 v117, v122, v123
    v_cvt_pk_bf16_f32 v118, v124, v125
    v_cvt_pk_bf16_f32 v119, v126, v127
    v_exp_f32 v128, v128
    buffer_load_dwordx4 a[128:131], v2, s[12:15], s26 offen offset:0 sc1
    v_exp_f32 v129, v129
    v_mfma_f32_32x32x16_bf16 v[208:223], a[72:75], v[112:115], v[208:223]
    v_exp_f32 v130, v130
    v_exp_f32 v131, v131
    v_exp_f32 v132, v132
    buffer_load_dwordx4 a[132:135], v2, s[12:15], s27 offen offset:0 sc1
    v_exp_f32 v133, v133
    s_cmp_lt_u32 s19, 2
    s_cbranch_scc1 P2S06
    v_mfma_f32_32x32x16_bf16 v[160:175], a[32:35], a[0:3], v[224:239]
P2S06:
    v_exp_f32 v134, v134
    v_exp_f32 v135, v135
    s_nop 0
    v_cvt_pk_bf16_f32 v128, v128, v129
    v_cvt_pk_bf16_f32 v129, v130, v131
    v_cvt_pk_bf16_f32 v130, v132, v133
    v_cvt_pk_bf16_f32 v131, v134, v135
    v_exp_f32 v136, v136
    buffer_load_dwordx4 a[136:139], v2, s[12:15], s26 offen offset:1024 sc1
    v_exp_f32 v137, v137
    v_mfma_f32_32x32x16_bf16 v[208:223], a[76:79], v[116:119], v[208:223]
    v_exp_f32 v138, v138
    v_exp_f32 v139, v139
    v_exp_f32 v140, v140
    buffer_load_dwordx4 a[140:143], v2, s[12:15], s27 offen offset:1024 sc1
    v_exp_f32 v141, v141
    v_exp_f32 v142, v142
    v_exp_f32 v143, v143
    s_nop 0
    v_cvt_pk_bf16_f32 v132, v136, v137
    v_cvt_pk_bf16_f32 v133, v138, v139
    v_cvt_pk_bf16_f32 v134, v140, v141
    v_cvt_pk_bf16_f32 v135, v142, v143
    v_exp_f32 v144, v144
    buffer_load_dwordx4 a[144:147], v2, s[12:15], s26 offen offset:2048 sc1
    v_exp_f32 v145, v145
    v_mfma_f32_32x32x16_bf16 v[208:223], a[80:83], v[128:131], v[208:223]
    v_exp_f32 v146, v146
    v_exp_f32 v147, v147
    v_exp_f32 v148, v148
    buffer_load_dwordx4 a[148:151], v2, s[12:15], s27 offen offset:2048 sc1
    v_exp_f32 v149, v149
    s_cmp_lt_u32 s19, 1
    s_cbranch_scc1 P2S07
    v_mfma_f32_32x32x16_bf16 v[176:191], a[36:39], a[0:3], v[224:239]
P2S07:
    v_exp_f32 v150, v150
    v_exp_f32 v151, v151
    s_nop 0
    v_cvt_pk_bf16_f32 v144, v144, v145
    v_cvt_pk_bf16_f32 v145, v146, v147
    v_cvt_pk_bf16_f32 v146, v148, v149
    v_cvt_pk_bf16_f32 v147, v150, v151
    v_exp_f32 v152, v152
    buffer_load_dwordx4 a[152:155], v2, s[12:15], s26 offen offset:3072 sc1
    s_add_u32 s26, s26, 4096
    v_exp_f32 v153, v153
    v_mfma_f32_32x32x16_bf16 v[208:223], a[84:87], v[132:135], v[208:223]
    v_exp_f32 v154, v154
    v_exp_f32 v155, v155
    v_exp_f32 v156, v156
    buffer_load_dwordx4 a[156:159], v2, s[12:15], s27 offen offset:3072 sc1
    s_add_u32 s27, s27, 4096
    v_exp_f32 v157, v157
    v_exp_f32 v158, v158
    v_exp_f32 v159, v159
    s_nop 0
    v_cvt_pk_bf16_f32 v148, v152, v153
    v_cvt_pk_bf16_f32 v149, v154, v155
    v_cvt_pk_bf16_f32 v150, v156, v157
    v_cvt_pk_bf16_f32 v151, v158, v159
    v_exp_f32 v160, v160
    buffer_load_dwordx4 a[160:163], v2, s[12:15], s26 offen offset:0 sc1
    v_exp_f32 v161, v161
    v_mfma_f32_32x32x16_bf16 v[208:223], a[88:91], v[144:147], v[208:223]
    v_exp_f32 v162, v162
    v_exp_f32 v163, v163
    v_exp_f32 v164, v164
    buffer_load_dwordx4 a[164:167], v2, s[12:15], s27 offen offset:0 sc1
    v_exp_f32 v165, v165
    v_exp_f32 v166, v166
    v_exp_f32 v167, v167
    s_nop 0
    v_cvt_pk_bf16_f32 v160, v160, v161
    v_cvt_pk_bf16_f32 v161, v162, v163
    v_cvt_pk_bf16_f32 v162, v164, v165
    v_cvt_pk_bf16_f32 v163, v166, v167
    v_exp_f32 v168, v168
    buffer_load_dwordx4 a[168:171], v2, s[12:15], s26 offen offset:1024 sc1
    v_exp_f32 v169, v169
    v_mfma_f32_32x32x16_bf16 v[208:223], a[92:95], v[148:151], v[208:223]
    v_exp_f32 v170, v170
    v_exp_f32 v171, v171
    v_exp_f32 v172, v172
    buffer_load_dwordx4 a[172:175], v2, s[12:15], s27 offen offset:1024 sc1
    v_exp_f32 v173, v173
    v_exp_f32 v174, v174
    v_exp_f32 v175, v175
    s_nop 0
    v_cvt_pk_bf16_f32 v164, v168, v169
    v_cvt_pk_bf16_f32 v165, v170, v171
    v_cvt_pk_bf16_f32 v166, v172, v173
    v_cvt_pk_bf16_f32 v167, v174, v175
    v_exp_f32 v176, v176
    buffer_load_dwordx4 a[176:179], v2, s[12:15], s26 offen offset:2048 sc1
    v_exp_f32 v177, v177
    v_mfma_f32_32x32x16_bf16 v[208:223], a[96:99], v[160:163], v[208:223]
    v_exp_f32 v178, v178
    v_exp_f32 v179, v179
    v_exp_f32 v180, v180
    buffer_load_dwordx4 a[180:183], v2, s[12:15], s27 offen offset:2048 sc1
    v_exp_f32 v181, v181
    v_exp_f32 v182, v182
    v_exp_f32 v183, v183
    s_nop 0
    v_cvt_pk_bf16_f32 v176, v176, v177
    v_cvt_pk_bf16_f32 v177, v178, v179
    v_cvt_pk_bf16_f32 v178, v180, v181
    v_cvt_pk_bf16_f32 v179, v182, v183
    v_exp_f32 v184, v184
    buffer_load_dwordx4 a[184:187], v2, s[12:15], s26 offen offset:3072 sc1
    s_add_u32 s26, s26, 4096
    v_exp_f32 v185, v185
    v_mfma_f32_32x32x16_bf16 v[208:223], a[100:103], v[164:167], v[208:223]
    v_exp_f32 v186, v186
    v_exp_f32 v187, v187
    v_exp_f32 v188, v188
    buffer_load_dwordx4 a[188:191], v2, s[12:15], s27 offen offset:3072 sc1
    s_add_u32 s27, s27, 4096
    v_exp_f32 v189, v189
    v_exp_f32 v190, v190
    v_exp_f32 v191, v191
    s_nop 0
    v_cvt_pk_bf16_f32 v180, v184, v185
    v_cvt_pk_bf16_f32 v181, v186, v187
    v_cvt_pk_bf16_f32 v182, v188, v189
    v_cvt_pk_bf16_f32 v183, v190, v191
    s_nop 1
    v_mfma_f32_32x32x16_bf16 v[208:223], a[104:107], v[176:179], v[208:223]
    v_mfma_f32_32x32x16_bf16 v[208:223], a[108:111], v[180:183], v[208:223]
    s_nop 7
    s_nop 3
    v_rcp_f32 v8, v216
    s_nop 0
    v_mul_f32 v208, v208, v8
    v_mul_f32 v209, v209, v8
    v_mul_f32 v210, v210, v8
    v_mul_f32 v211, v211, v8
    v_mul_f32 v212, v212, v8
    v_mul_f32 v213, v213, v8
    v_mul_f32 v214, v214, v8
    v_mul_f32 v215, v215, v8
    v_cvt_pk_bf16_f32 v24, v208, v209
    v_cvt_pk_bf16_f32 v25, v210, v211
    v_cvt_pk_bf16_f32 v26, v212, v213
    v_cvt_pk_bf16_f32 v27, v214, v215
    buffer_store_dwordx4 v[24:27], v2, s[12:15], s25 offen sc1
    s_add_u32 s25, s25, 32768
    v_mfma_f32_32x32x16_bf16 v[192:207], a[44:47], a[4:7], 0
    s_cmp_lt_u32 s19, 7
    s_cbranch_scc1 P2F10
    v_mfma_f32_32x32x16_bf16 v[64:79], a[12:15], a[4:7], 0
P2N10:
    s_cmp_lt_u32 s19, 6
    s_cbranch_scc1 P2F11
    v_mfma_f32_32x32x16_bf16 v[80:95], a[16:19], a[4:7], 0
P2N11:
    s_cmp_lt_u32 s19, 5
    s_cbranch_scc1 P2F12
    v_mfma_f32_32x32x16_bf16 v[96:111], a[20:23], a[4:7], 0
P2N12:
    s_cmp_lt_u32 s19, 4
    s_cbranch_scc1 P2F13
    v_mfma_f32_32x32x16_bf16 v[112:127], a[24:27], a[4:7], 0
P2N13:
    s_cmp_lt_u32 s19, 3
    s_cbranch_scc1 P2F14
    v_mfma_f32_32x32x16_bf16 v[128:143], a[28:31], a[4:7], 0
P2N14:
    s_cmp_lt_u32 s19, 2
    s_cbranch_scc1 P2F15
    v_mfma_f32_32x32x16_bf16 v[144:159], a[32:35], a[4:7], 0
P2N15:
    s_cmp_lt_u32 s19, 1
    s_cbranch_scc1 P2F16
    v_mfma_f32_32x32x16_bf16 v[160:175], a[36:39], a[4:7], 0
P2N16:
    s_cmp_lt_u32 s19, 0
    s_cbranch_scc1 P2F17
    v_mfma_f32_32x32x16_bf16 v[176:191], a[40:43], a[4:7], 0
P2N17:
    v_cmp_le_i32 s[32:33], 0, v14
    v_cmp_le_i32 s[34:35], 1, v14
    v_cmp_le_i32 s[36:37], 2, v14
    v_cmp_le_i32 s[38:39], 3, v14
    v_cndmask_b32 v64, v64, v192, s[32:33]
    v_cndmask_b32 v65, v65, v193, s[34:35]
    v_cndmask_b32 v66, v66, v194, s[36:37]
    v_cndmask_b32 v67, v67, v195, s[38:39]
    v_cmp_le_i32 s[32:33], 8, v14
    v_cmp_le_i32 s[34:35], 9, v14
    v_cmp_le_i32 s[36:37], 10, v14
    v_cmp_le_i32 s[38:39], 11, v14
    v_cndmask_b32 v68, v68, v196, s[32:33]
    v_cndmask_b32 v69, v69, v197, s[34:35]
    v_cndmask_b32 v70, v70, v198, s[36:37]
    v_cndmask_b32 v71, v71, v199, s[38:39]
    v_cmp_le_i32 s[32:33], 16, v14
    v_cmp_le_i32 s[34:35], 17, v14
    v_cmp_le_i32 s[36:37], 18, v14
    v_cmp_le_i32 s[38:39], 19, v14
    v_cndmask_b32 v72, v72, v200, s[32:33]
    v_cndmask_b32 v73, v73, v201, s[34:35]
    v_cndmask_b32 v74, v74, v202, s[36:37]
    v_cndmask_b32 v75, v75, v203, s[38:39]
    v_cmp_le_i32 s[32:33], 24, v14
    v_cmp_le_i32 s[34:35], 25, v14
    v_cmp_le_i32 s[36:37], 26, v14
    v_cmp_le_i32 s[38:39], 27, v14
    v_cndmask_b32 v76, v76, v204, s[32:33]
    v_cndmask_b32 v77, v77, v205, s[34:35]
    v_cndmask_b32 v78, v78, v206, s[36:37]
    v_cndmask_b32 v79, v79, v207, s[38:39]
    v_max3_f32 v8, v64, v65, v66
    v_max3_f32 v9, v67, v68, v69
    v_max3_f32 v8, v8, v70, v71
    v_max3_f32 v9, v9, v72, v73
    buffer_load_dwordx4 a[192:195], v10, s[8:11], s28 offen offset:0
    v_max3_f32 v8, v8, v74, v75
    v_max3_f32 v9, v9, v76, v77
    v_max3_f32 v8, v8, v78, v79
    v_max3_f32 v9, v9, v80, v81
    v_max3_f32 v8, v8, v82, v83
    v_max3_f32 v9, v9, v84, v85
    v_max3_f32 v8, v8, v86, v87
    v_max3_f32 v9, v9, v88, v89
    buffer_load_dwordx4 a[196:199], v10, s[8:11], s28 offen offset:32
    v_max3_f32 v8, v8, v90, v91
    v_max3_f32 v9, v9, v92, v93
    v_max3_f32 v8, v8, v94, v95
    v_max3_f32 v9, v9, v96, v97
    v_max3_f32 v8, v8, v98, v99
    v_max3_f32 v9, v9, v100, v101
    v_max3_f32 v8, v8, v102, v103
    v_max3_f32 v9, v9, v104, v105
    buffer_load_dwordx4 a[200:203], v11, s[12:15], s30 offen offset:0 sc1
    v_max3_f32 v8, v8, v106, v107
    v_max3_f32 v9, v9, v108, v109
    v_max3_f32 v8, v8, v110, v111
    v_max3_f32 v9, v9, v112, v113
    v_max3_f32 v8, v8, v114, v115
    v_max3_f32 v9, v9, v116, v117
    v_max3_f32 v8, v8, v118, v119
    v_max3_f32 v9, v9, v120, v121
    buffer_load_dwordx4 a[216:219], v11, s[12:15], s31 offen offset:0 sc1
    v_max3_f32 v8, v8, v122, v123
    v_max3_f32 v9, v9, v124, v125
    v_max3_f32 v8, v8, v126, v127
    v_max3_f32 v9, v9, v128, v129
    v_max3_f32 v8, v8, v130, v131
    v_max3_f32 v9, v9, v132, v133
    v_max3_f32 v8, v8, v134, v135
    v_max3_f32 v9, v9, v136, v137
    buffer_load_dwordx4 a[204:207], v11, s[12:15], s30 offen offset:32 sc1
    v_max3_f32 v8, v8, v138, v139
    v_max3_f32 v9, v9, v140, v141
    v_max3_f32 v8, v8, v142, v143
    v_max3_f32 v9, v9, v144, v145
    v_max3_f32 v8, v8, v146, v147
    v_max3_f32 v9, v9, v148, v149
    v_max3_f32 v8, v8, v150, v151
    v_max3_f32 v9, v9, v152, v153
    buffer_load_dwordx4 a[220:223], v11, s[12:15], s31 offen offset:32 sc1
    v_max3_f32 v8, v8, v154, v155
    v_max3_f32 v9, v9, v156, v157
    v_max3_f32 v8, v8, v158, v159
    v_max3_f32 v9, v9, v160, v161
    v_max3_f32 v8, v8, v162, v163
    v_max3_f32 v9, v9, v164, v165
    v_max3_f32 v8, v8, v166, v167
    v_max3_f32 v9, v9, v168, v169
    buffer_load_dwordx4 a[208:211], v11, s[12:15], s30 offen offset:64 sc1
    v_max3_f32 v8, v8, v170, v171
    v_max3_f32 v9, v9, v172, v173
    v_max3_f32 v8, v8, v174, v175
    v_max3_f32 v9, v9, v176, v177
    v_max3_f32 v8, v8, v178, v179
    v_max3_f32 v9, v9, v180, v181
    v_max3_f32 v8, v8, v182, v183
    v_max3_f32 v9, v9, v184, v185
    buffer_load_dwordx4 a[224:227], v11, s[12:15], s31 offen offset:64 sc1
    v_max3_f32 v8, v8, v186, v187
    v_max3_f32 v9, v9, v188, v189
    v_max3_f32 v8, v8, v190, v191
    v_max_f32 v8, v8, v9
    v_mov_b32 v9, v8
    s_nop 1
    v_permlane32_swap_b32 v8, v9
    v_max_f32 v8, v8, v9
    v_sub_f32 v224, 0, v8
    v_sub_f32 v225, 0, v8
    v_sub_f32 v226, 0, v8
    v_sub_f32 v227, 0, v8
    v_sub_f32 v228, 0, v8
    v_sub_f32 v229, 0, v8
    v_sub_f32 v230, 0, v8
    v_sub_f32 v231, 0, v8
    v_sub_f32 v232, 0, v8
    v_sub_f32 v233, 0, v8
    v_sub_f32 v234, 0, v8
    v_sub_f32 v235, 0, v8
    v_sub_f32 v236, 0, v8
    v_sub_f32 v237, 0, v8
    v_sub_f32 v238, 0, v8
    v_sub_f32 v239, 0, v8
    s_cmp_lt_u32 s19, 6
    s_cbranch_scc1 P2S11
    v_mfma_f32_32x32x16_bf16 v[80:95], a[16:19], a[4:7], v[224:239]
P2S11:
    v_sub_f32 v64, v64, v8
    v_sub_f32 v65, v65, v8
    v_sub_f32 v66, v66, v8
    v_sub_f32 v67, v67, v8
    v_sub_f32 v68, v68, v8
    v_sub_f32 v69, v69, v8
    v_sub_f32 v70, v70, v8
    v_sub_f32 v71, v71, v8
    v_sub_f32 v72, v72, v8
    v_sub_f32 v73, v73, v8
    v_sub_f32 v74, v74, v8
    v_sub_f32 v75, v75, v8
    v_sub_f32 v76, v76, v8
    v_sub_f32 v77, v77, v8
    v_sub_f32 v78, v78, v8
    v_sub_f32 v79, v79, v8
    v_exp_f32 v64, v64
    buffer_load_dwordx4 a[212:215], v11, s[12:15], s30 offen offset:96 sc1
    v_exp_f32 v65, v65
    v_exp_f32 v66, v66
    v_exp_f32 v67, v67
    v_exp_f32 v68, v68
    buffer_load_dwordx4 a[228:231], v11, s[12:15], s31 offen offset:96 sc1
    v_exp_f32 v69, v69
    s_cmp_lt_u32 s19, 5
    s_cbranch_scc1 P2S12
    v_mfma_f32_32x32x16_bf16 v[96:111], a[20:23], a[4:7], v[224:239]
P2S12:
    v_exp_f32 v70, v70
    v_exp_f32 v71, v71
    s_nop 0
    v_cvt_pk_bf16_f32 v64, v64, v65
    v_cvt_pk_bf16_f32 v65, v66, v67
    v_cvt_pk_bf16_f32 v66, v68, v69
    v_cvt_pk_bf16_f32 v67, v70, v71
    v_exp_f32 v72, v72
    s_mov_b32 m0, s43
    s_nop 0
    buffer_load_dwordx4 v2, s[12:15], s42 offen offset:0 sc1 lds
    v_exp_f32 v73, v73
    v_exp_f32 v74, v74
    v_exp_f32 v75, v75
    v_exp_f32 v76, v76
    buffer_load_dwordx4 v2, s[12:15], s42 offen offset:1024 sc1 lds
    v_exp_f32 v77, v77
    v_exp_f32 v78, v78
    v_exp_f32 v79, v79
    s_nop 0
    v_cvt_pk_bf16_f32 v68, v72, v73
    v_cvt_pk_bf16_f32 v69, v74, v75
    v_cvt_pk_bf16_f32 v70, v76, v77
    v_cvt_pk_bf16_f32 v71, v78, v79
    v_and_b32 v72, v240, v64
    v_xor_b32 v64, v72, v64
    v_and_b32 v73, v241, v65
    v_xor_b32 v65, v73, v65
    v_and_b32 v74, v242, v66
    v_xor_b32 v66, v74, v66
    v_and_b32 v75, v243, v67
    v_xor_b32 v67, v75, v67
    v_and_b32 v76, v244, v68
    v_xor_b32 v68, v76, v68
    v_and_b32 v77, v245, v69
    v_xor_b32 v69, v77, v69
    v_and_b32 v78, v246, v70
    v_xor_b32 v70, v78, v70
    v_and_b32 v79, v247, v71
    v_xor_b32 v71, v79, v71
    v_exp_f32 v80, v80
    buffer_load_dwordx4 v2, s[12:15], s42 offen offset:2048 sc1 lds
    v_exp_f32 v81, v81
    v_mfma_f32_32x32x16_bf16 v[208:223], a[56:59], v[64:67], 0
    v_exp_f32 v82, v82
    v_exp_f32 v83, v83
    v_exp_f32 v84, v84
    buffer_load_dwordx4 v2, s[12:15], s42 offen offset:3072 sc1 lds
    s_add_u32 s42, s42, 16384
    s_add_u32 s43, s43, 16384
    v_exp_f32 v85, v85
    s_cmp_lt_u32 s19, 4
    s_cbranch_scc1 P2S13
    v_mfma_f32_32x32x16_bf16 v[112:127], a[24:27], a[4:7], v[224:239]
P2S13:
    v_exp_f32 v86, v86
    v_exp_f32 v87, v87
    s_nop 0
    v_cvt_pk_bf16_f32 v80, v80, v81
    v_cvt_pk_bf16_f32 v81, v82, v83
    v_cvt_pk_bf16_f32 v82, v84, v85
    v_cvt_pk_bf16_f32 v83, v86, v87
    v_exp_f32 v88, v88
    s_mov_b32 m0, s43
    s_nop 0
    buffer_load_dwordx4 v2, s[12:15], s42 offen offset:0 sc1 lds
    v_exp_f32 v89, v89
    v_mfma_f32_32x32x16_bf16 v[208:223], a[60:63], v[68:71], v[208:223]
    v_exp_f32 v90, v90
    v_exp_f32 v91, v91
    v_exp_f32 v92, v92
    buffer_load_dwordx4 v2, s[12:15], s42 offen offset:1024 sc1 lds
    v_exp_f32 v93, v93
    v_mfma_f32_32x32x16_bf16 v[208:223], a[120:123], v[72:75], v[208:223]
    v_exp_f32 v94, v94
    v_exp_f32 v95, v95
    s_nop 0
    v_cvt_pk_bf16_f32 v84, v88, v89
    v_cvt_pk_bf16_f32 v85, v90, v91
    v_cvt_pk_bf16_f32 v86, v92, v93
    v_cvt_pk_bf16_f32 v87, v94, v95
    v_exp_f32 v96, v96
    buffer_load_dwordx4 v2, s[12:15], s42 offen offset:2048 sc1 lds
    v_exp_f32 v97, v97
    v_mfma_f32_32x32x16_bf16 v[208:223], a[124:127], v[76:79], v[208:223]
    v_exp_f32 v98, v98
    v_exp_f32 v99, v99
    v_exp_f32 v100, v100
    buffer_load_dwordx4 v2, s[12:15], s42 offen offset:3072 sc1 lds
    s_add_u32 s42, s42, 16384
    s_add_u32 s43, s43, 16384
    v_exp_f32 v101, v101
    s_cmp_lt_u32 s19, 3
    s_cbranch_scc1 P2S14
    v_mfma_f32_32x32x16_bf16 v[128:143], a[28:31], a[4:7], v[224:239]
P2S14:
    v_exp_f32 v102, v102
    v_exp_f32 v103, v103
    s_nop 0
    v_cvt_pk_bf16_f32 v96, v96, v97
    v_cvt_pk_bf16_f32 v97, v98, v99
    v_cvt_pk_bf16_f32 v98, v100, v101
    v_cvt_pk_bf16_f32 v99, v102, v103
    v_exp_f32 v104, v104
    s_mov_b32 m0, s43
    s_nop 0
    buffer_load_dwordx4 v2, s[12:15], s42 offen offset:0 sc1 lds
    v_exp_f32 v105, v105
    v_mfma_f32_32x32x16_bf16 v[208:223], a[64:67], v[80:83], v[208:223]
    v_exp_f32 v106, v106
    v_exp_f32 v107, v107
    v_exp_f32 v108, v108
    buffer_load_dwordx4 v2, s[12:15], s42 offen offset:1024 sc1 lds
    v_exp_f32 v109, v109
    v_mfma_f32_32x32x16_bf16 v[208:223], a[68:71], v[84:87], v[208:223]
    v_exp_f32 v110, v110
    v_exp_f32 v111, v111
    s_nop 0
    v_cvt_pk_bf16_f32 v100, v104, v105
    v_cvt_pk_bf16_f32 v101, v106, v107
    v_cvt_pk_bf16_f32 v102, v108, v109
    v_cvt_pk_bf16_f32 v103, v110, v111
    v_exp_f32 v112, v112
    buffer_load_dwordx4 v2, s[12:15], s42 offen offset:2048 sc1 lds
    v_exp_f32 v113, v113
    v_mfma_f32_32x32x16_bf16 v[208:223], a[72:75], v[96:99], v[208:223]
    v_exp_f32 v114, v114
    v_exp_f32 v115, v115
    v_exp_f32 v116, v116
    buffer_load_dwordx4 v2, s[12:15], s42 offen offset:3072 sc1 lds
    s_add_u32 s42, s42, 16384
    s_add_u32 s43, s43, 16384
    v_exp_f32 v117, v117
    s_cmp_lt_u32 s19, 2
    s_cbranch_scc1 P2S15
    v_mfma_f32_32x32x16_bf16 v[144:159], a[32:35], a[4:7], v[224:239]
P2S15:
    v_exp_f32 v118, v118
    v_exp_f32 v119, v119
    s_nop 0
    v_cvt_pk_bf16_f32 v112, v112, v113
    v_cvt_pk_bf16_f32 v113, v114, v115
    v_cvt_pk_bf16_f32 v114, v116, v117
    v_cvt_pk_bf16_f32 v115, v118, v119
    v_exp_f32 v120, v120
    s_mov_b32 m0, s43
    s_nop 0
    buffer_load_dwordx4 v2, s[12:15], s42 offen offset:0 sc1 lds
    v_exp_f32 v121, v121
    v_mfma_f32_32x32x16_bf16 v[208:223], a[76:79], v[100:103], v[208:223]
    v_exp_f32 v122, v122
    v_exp_f32 v123, v123
    v_exp_f32 v124, v124
    buffer_load_dwordx4 v2, s[12:15], s42 offen offset:1024 sc1 lds
    v_exp_f32 v125, v125
    v_exp_f32 v126, v126
    v_exp_f32 v127, v127
    s_nop 0
    v_cvt_pk_bf16_f32 v116, v120, v121
    v_cvt_pk_bf16_f32 v117, v122, v123
    v_cvt_pk_bf16_f32 v118, v124, v125
    v_cvt_pk_bf16_f32 v119, v126, v127
    v_exp_f32 v128, v128
    buffer_load_dwordx4 v2, s[12:15], s42 offen offset:2048 sc1 lds
    s_waitcnt vmcnt(33)
    s_cmp_ge_u32 s2, 112
    s_cbranch_scc1 JF_B9
    v_lshrrev_b32 v52, 5, v1
    v_bfe_u32 v53, v1, 2, 2
    v_bfe_u32 v54, v1, 4, 1
    v_and_b32 v55, 3, v1
    v_bfe_u32 v56, v1, 3, 1
    v_lshlrev_b32 v48, 7, v53
    v_lshl_add_u32 v48, v55, 3, v48
    v_lshl_add_u32 v48, v54, 5, v48
    v_lshl_add_u32 v48, v56, 6, v48
    v_lshl_add_u32 v48, v52, 9, v48
    v_add_u32 v48, s56, v48
    v_xor_b32 v49, 64, v48
    v_add_u32 v50, 2048, v48
    v_add_u32 v51, 2048, v49
    ds_read_b64_tr_b16 v[32:33], v48
    ds_read_b64_tr_b16 v[34:35], v48 offset:1024
    ds_read_b64_tr_b16 v[36:37], v49
    ds_read_b64_tr_b16 v[38:39], v49 offset:1024
    ds_read_b64_tr_b16 v[40:41], v50
    ds_read_b64_tr_b16 v[42:43], v50 offset:1024
    ds_read_b64_tr_b16 v[44:45], v51
    ds_read_b64_tr_b16 v[46:47], v51 offset:1024
    s_waitcnt lgkmcnt(0)
    buffer_store_dwordx4 v[32:35], v2, s[12:15], s44 offen sc1
    buffer_store_dwordx4 v[36:39], v2, s[12:15], s45 offen sc1
    buffer_store_dwordx4 v[40:43], v2, s[12:15], s46 offen sc1
    buffer_store_dwordx4 v[44:47], v2, s[12:15], s47 offen sc1
JF_B9:
    v_exp_f32 v129, v129
    v_mfma_f32_32x32x16_bf16 v[208:223], a[80:83], v[112:115], v[208:223]
    v_exp_f32 v130, v130
    v_exp_f32 v131, v131
    v_exp_f32 v132, v132
    buffer_load_dwordx4 v2, s[12:15], s42 offen offset:3072 sc1 lds
    s_add_u32 s42, s42, 16384
    s_add_u32 s43, s43, 16384
    v_exp_f32 v133, v133
    s_cmp_lt_u32 s19, 1
    s_cbranch_scc1 P2S16
    v_mfma_f32_32x32x16_bf16 v[160:175], a[36:39], a[4:7], v[224:239]
P2S16:
    v_exp_f32 v134, v134
    v_exp_f32 v135, v135
    s_nop 0
    v_cvt_pk_bf16_f32 v128, v128, v129
    v_cvt_pk_bf16_f32 v129, v130, v131
    v_cvt_pk_bf16_f32 v130, v132, v133
    v_cvt_pk_bf16_f32 v131, v134, v135
    v_exp_f32 v136, v136
    v_exp_f32 v137, v137
    v_mfma_f32_32x32x16_bf16 v[208:223], a[84:87], v[116:119], v[208:223]
    v_exp_f32 v138, v138
    v_exp_f32 v139, v139
    v_exp_f32 v140, v140
    v_exp_f32 v141, v141
    v_exp_f32 v142, v142
    v_exp_f32 v143, v143
    s_nop 0
    v_cvt_pk_bf16_f32 v132, v136, v137
    v_cvt_pk_bf16_f32 v133, v138, v139
    v_cvt_pk_bf16_f32 v134, v140, v141
    v_cvt_pk_bf16_f32 v135, v142, v143
    v_exp_f32 v144, v144
    v_exp_f32 v145, v145
    v_mfma_f32_32x32x16_bf16 v[208:223], a[88:91], v[128:131], v[208:223]
    v_exp_f32 v146, v146
    v_exp_f32 v147, v147
    v_exp_f32 v148, v148
    v_exp_f32 v149, v149
    s_cmp_lt_u32 s19, 0
    s_cbranch_scc1 P2S17
    v_mfma_f32_32x32x16_bf16 v[176:191], a[40:43], a[4:7], v[224:239]
P2S17:
    v_exp_f32 v150, v150
    v_exp_f32 v151, v151
    s_nop 0
    v_cvt_pk_bf16_f32 v144, v144, v145
    v_cvt_pk_bf16_f32 v145, v146, v147
    v_cvt_pk_bf16_f32 v146, v148, v149
    v_cvt_pk_bf16_f32 v147, v150, v151
    v_exp_f32 v152, v152
    v_exp_f32 v153, v153
    v_mfma_f32_32x32x16_bf16 v[208:223], a[92:95], v[132:135], v[208:223]
    v_exp_f32 v154, v154
    v_exp_f32 v155, v155
    v_exp_f32 v156, v156
    v_exp_f32 v157, v157
    v_exp_f32 v158, v158
    v_exp_f32 v159, v159
    s_nop 0
    v_cvt_pk_bf16_f32 v148, v152, v153
    v_cvt_pk_bf16_f32 v149, v154, v155
    v_cvt_pk_bf16_f32 v150, v156, v157
    v_cvt_pk_bf16_f32 v151, v158, v159
    v_exp_f32 v160, v160
    v_exp_f32 v161, v161
    v_mfma_f32_32x32x16_bf16 v[208:223], a[96:99], v[144:147], v[208:223]
    v_exp_f32 v162, v162
    v_exp_f32 v163, v163
    v_exp_f32 v164, v164
    v_exp_f32 v165, v165
    v_exp_f32 v166, v166
    v_exp_f32 v167, v167
    s_nop 0
    v_cvt_pk_bf16_f32 v160, v160, v161
    v_cvt_pk_bf16_f32 v161, v162, v163
    v_cvt_pk_bf16_f32 v162, v164, v165
    v_cvt_pk_bf16_f32 v163, v166, v167
    v_exp_f32 v168, v168
    v_exp_f32 v169, v169
    v_mfma_f32_32x32x16_bf16 v[208:223], a[100:103], v[148:151], v[208:223]
    v_exp_f32 v170, v170
    v_exp_f32 v171, v171
    v_exp_f32 v172, v172
    v_exp_f32 v173, v173
    v_exp_f32 v174, v174
    v_exp_f32 v175, v175
    s_nop 0
    v_cvt_pk_bf16_f32 v164, v168, v169
    v_cvt_pk_bf16_f32 v165, v170, v171
    v_cvt_pk_bf16_f32 v166, v172, v173
    v_cvt_pk_bf16_f32 v167, v174, v175
    v_exp_f32 v176, v176
    v_exp_f32 v177, v177
    v_mfma_f32_32x32x16_bf16 v[208:223], a[104:107], v[160:163], v[208:223]
    v_exp_f32 v178, v178
    v_exp_f32 v179, v179
    v_exp_f32 v180, v180
    v_exp_f32 v181, v181
    v_exp_f32 v182, v182
    v_exp_f32 v183, v183
    s_nop 0
    v_cvt_pk_bf16_f32 v176, v176, v177
    v_cvt_pk_bf16_f32 v177, v178, v179
    v_cvt_pk_bf16_f32 v178, v180, v181
    v_cvt_pk_bf16_f32 v179, v182, v183
    v_exp_f32 v184, v184
    v_exp_f32 v185, v185
    v_mfma_f32_32x32x16_bf16 v[208:223], a[108:111], v[164:167], v[208:223]
    v_exp_f32 v186, v186
    v_exp_f32 v187, v187
    v_exp_f32 v188, v188
    v_exp_f32 v189, v189
    v_exp_f32 v190, v190
    v_exp_f32 v191, v191
    s_nop 0
    v_cvt_pk_bf16_f32 v180, v184, v185
    v_cvt_pk_bf16_f32 v181, v186, v187
    v_cvt_pk_bf16_f32 v182, v188, v189
    v_cvt_pk_bf16_f32 v183, v190, v191
    s_nop 1
    v_mfma_f32_32x32x16_bf16 v[208:223], a[112:115], v[176:179], v[208:223]
    v_mfma_f32_32x32x16_bf16 v[208:223], a[116:119], v[180:183], v[208:223]
    s_nop 7
    s_nop 3
    v_rcp_f32 v8, v216
    s_nop 0
    v_mul_f32 v208, v208, v8
    v_mul_f32 v209, v209, v8
    v_mul_f32 v210, v210, v8
    v_mul_f32 v211, v211, v8
    v_mul_f32 v212, v212, v8
    v_mul_f32 v213, v213, v8
    v_mul_f32 v214, v214, v8
    v_mul_f32 v215, v215, v8
    v_cvt_pk_bf16_f32 v28, v208, v209
    v_cvt_pk_bf16_f32 v29, v210, v211
    v_cvt_pk_bf16_f32 v30, v212, v213
    v_cvt_pk_bf16_f32 v31, v214, v215
    buffer_store_dwordx4 v[28:31], v2, s[12:15], s25 offen sc1
    s_add_u32 s25, s25, 32768
    s_waitcnt vmcnt(0)
    s_barrier
    s_cmp_lg_u32 s4, 0
    s_cbranch_scc1 PB9
    s_lshl_b32 s98, s7, 3
    s_add_u32 s98, s98, 595968
    v_mov_b32 v252, s96
    v_mov_b32 v253, s97
    v_mov_b32 v254, 0
    s_mov_b64 exec, 1
    buffer_store_dwordx2 v[252:253], v254, s[12:15], s98 offen sc1
    s_mov_b64 exec, -1
PB9:
    s_cmp_lg_u32 s4, 0
    s_cbranch_scc1 PB10
    s_lshl_b32 s98, s2, 3
    s_add_u32 s98, s98, 598016
    v_mov_b32 v252, s96
    v_mov_b32 v253, s97
    v_mov_b32 v254, 0
    s_mov_b64 exec, 1
    buffer_store_dwordx2 v[252:253], v254, s[12:15], s98 offen sc1
    s_mov_b64 exec, -1
PB10:
    s_mov_b32 m0, s43
    s_nop 0
    buffer_load_dwordx4 v2, s[12:15], s42 offen offset:0 sc1 lds
    buffer_load_dwordx4 v2, s[12:15], s42 offen offset:1024 sc1 lds
    buffer_load_dwordx4 v2, s[12:15], s42 offen offset:2048 sc1 lds
    buffer_load_dwordx4 v2, s[12:15], s42 offen offset:3072 sc1 lds
    s_add_u32 s42, s42, 16384
    s_add_u32 s43, s43, 16384
    s_mov_b32 m0, s43
    s_nop 0
    buffer_load_dwordx4 v2, s[12:15], s42 offen offset:0 sc1 lds
    buffer_load_dwordx4 v2, s[12:15], s42 offen offset:1024 sc1 lds
    buffer_load_dwordx4 v2, s[12:15], s42 offen offset:2048 sc1 lds
    buffer_load_dwordx4 v2, s[12:15], s42 offen offset:3072 sc1 lds
    s_add_u32 s42, s42, 16384
    s_add_u32 s43, s43, 16384
    s_mov_b32 m0, s43
    s_nop 0
    buffer_load_dwordx4 v2, s[12:15], s42 offen offset:0 sc1 lds
    buffer_load_dwordx4 v2, s[12:15], s42 offen offset:1024 sc1 lds
    buffer_load_dwordx4 v2, s[12:15], s42 offen offset:2048 sc1 lds
    buffer_load_dwordx4 v2, s[12:15], s42 offen offset:3072 sc1 lds
    s_add_u32 s42, s42, 16384
    s_add_u32 s43, s43, 16384
    v_and_b32 v12, 7, v1
    v_lshlrev_b32 v12, 3, v12
    s_lshl_b32 s28, s3, 6
    v_add_u32 v12, s28, v12
    s_lshl_b32 s35, s3, 3
    s_add_u32 s35, s35, s63
    s_cmp_lg_u32 s4, 0
    s_cbranch_scc1 PD11
    s_mov_b32 s99, 0
PL11:
    s_mov_b32 s98, 595968
    buffer_load_dwordx2 v[240:241], v12, s[12:15], s98 offen sc1
    s_add_u32 s99, s99, 1
    s_waitcnt vmcnt(0)
    v_cmp_ne_u64 vcc, s[96:97], v[240:241]
    s_cmp_eq_u64 vcc, 0
    s_cbranch_scc1 PD11
    s_sleep 2
    s_cmp_lt_u32 s99, 50000
    s_cbranch_scc1 PL11
PD11:
    s_waitcnt vmcnt(0)
    s_barrier
    buffer_load_dwordx4 a[0:3], v2, s[12:15], s16 offen offset:0 sc1
    buffer_load_dwordx4 a[4:7], v2, s[12:15], s17 offen offset:0 sc1
    buffer_load_dwordx4 a[8:11], v2, s[12:15], s16 offen offset:1024 sc1
    buffer_load_dwordx4 a[12:15], v2, s[12:15], s17 offen offset:1024 sc1
    buffer_load_dwordx4 a[16:19], v2, s[12:15], s16 offen offset:2048 sc1
    buffer_load_dwordx4 a[20:23], v2, s[12:15], s17 offen offset:2048 sc1
    buffer_load_dwordx4 a[24:27], v2, s[12:15], s16 offen offset:3072 sc1
    s_add_u32 s16, s16, 4096
    buffer_load_dwordx4 a[28:31], v2, s[12:15], s17 offen offset:3072 sc1
    s_add_u32 s17, s17, 4096
    buffer_load_dwordx4 a[32:35], v2, s[12:15], s16 offen offset:0 sc1
    buffer_load_dwordx4 a[36:39], v2, s[12:15], s17 offen offset:0 sc1
    buffer_load_dwordx4 a[40:43], v2, s[12:15], s16 offen offset:1024 sc1
    buffer_load_dwordx4 a[44:47], v2, s[12:15], s17 offen offset:1024 sc1
    buffer_load_dwordx4 a[48:51], v2, s[12:15], s16 offen offset:2048 sc1
    buffer_load_dwordx4 a[52:55], v2, s[12:15], s17 offen offset:2048 sc1
    buffer_load_dwordx4 a[56:59], v2, s[12:15], s16 offen offset:3072 sc1
    s_add_u32 s16, s16, 4096
    buffer_load_dwordx4 a[60:63], v2, s[12:15], s17 offen offset:3072 sc1
    s_add_u32 s17, s17, 4096
    v_accvgpr_read_b32 v80, a192
    v_accvgpr_read_b32 v81, a193
    v_accvgpr_read_b32 v82, a194
    v_accvgpr_read_b32 v83, a195
    v_accvgpr_read_b32 v84, a196
    v_accvgpr_read_b32 v85, a197
    v_accvgpr_read_b32 v86, a198
    v_accvgpr_read_b32 v87, a199
    v_accvgpr_read_b32 v88, a200
    v_accvgpr_read_b32 v89, a201
    v_accvgpr_read_b32 v90, a202
    v_accvgpr_read_b32 v91, a203
    v_accvgpr_read_b32 v92, a204
    v_accvgpr_read_b32 v93, a205
    v_accvgpr_read_b32 v94, a206
    v_accvgpr_read_b32 v95, a207
    v_accvgpr_read_b32 v96, a208
    v_accvgpr_read_b32 v97, a209
    v_accvgpr_read_b32 v98, a210
    v_accvgpr_read_b32 v99, a211
    v_accvgpr_read_b32 v100, a212
    v_accvgpr_read_b32 v101, a213
    v_accvgpr_read_b32 v102, a214
    v_accvgpr_read_b32 v103, a215
    v_accvgpr_read_b32 v104, a216
    v_accvgpr_read_b32 v105, a217
    v_accvgpr_read_b32 v106, a218
    v_accvgpr_read_b32 v107, a219
    v_accvgpr_read_b32 v108, a220
    v_accvgpr_read_b32 v109, a221
    v_accvgpr_read_b32 v110, a222
    v_accvgpr_read_b32 v111, a223
    v_accvgpr_read_b32 v112, a224
    v_accvgpr_read_b32 v113, a225
    v_accvgpr_read_b32 v114, a226
    v_accvgpr_read_b32 v115, a227
    v_accvgpr_read_b32 v116, a228
    v_accvgpr_read_b32 v117, a229
    v_accvgpr_read_b32 v118, a230
    v_accvgpr_read_b32 v119, a231
    v_permlane32_swap_b32 v80, v82
    v_permlane32_swap_b32 v81, v83
    v_permlane32_swap_b32 v84, v86
    v_permlane32_swap_b32 v85, v87
    v_lshlrev_b32 v192, 16, v80
    v_and_b32 v193, 0xffff0000, v80
    v_lshlrev_b32 v194, 16, v81
    v_and_b32 v195, 0xffff0000, v81
    v_lshlrev_b32 v196, 16, v82
    v_and_b32 v197, 0xffff0000, v82
    v_lshlrev_b32 v198, 16, v83
    v_and_b32 v199, 0xffff0000, v83
    v_lshlrev_b32 v200, 16, v84
    v_and_b32 v201, 0xffff0000, v84
    v_lshlrev_b32 v202, 16, v85
    v_and_b32 v203, 0xffff0000, v85
    v_lshlrev_b32 v204, 16, v86
    v_and_b32 v205, 0xffff0000, v86
    v_lshlrev_b32 v206, 16, v87
    v_and_b32 v207, 0xffff0000, v87
    s_cmp_lt_u32 s2, 112
    s_cbranch_scc1 CV9
    s_cmp_ge_u32 s2, 224
    s_cbranch_scc1 CV9
    v_accvgpr_read_b32 v128, a232
    v_accvgpr_read_b32 v129, a233
    v_accvgpr_read_b32 v130, a234
    v_accvgpr_read_b32 v131, a235
    v_accvgpr_read_b32 v132, a236
    v_accvgpr_read_b32 v133, a237
    v_accvgpr_read_b32 v134, a238
    v_accvgpr_read_b32 v135, a239
    v_accvgpr_read_b32 v136, a240
    v_accvgpr_read_b32 v137, a241
    v_accvgpr_read_b32 v138, a242
    v_accvgpr_read_b32 v139, a243
    v_accvgpr_read_b32 v140, a244
    v_accvgpr_read_b32 v141, a245
    v_accvgpr_read_b32 v142, a246
    v_accvgpr_read_b32 v143, a247
    v_lshlrev_b32 v14, 16, v32
    v_and_b32 v15, 0xffff0000, v32
    v_pk_mul_f32 v[176:177], v[14:15], v[136:137] op_sel_hi:[1,0]
    v_pk_mul_f32 v[184:185], v[14:15], v[128:129] op_sel_hi:[1,0]
    v_lshlrev_b32 v14, 16, v33
    v_and_b32 v15, 0xffff0000, v33
    v_pk_mul_f32 v[178:179], v[14:15], v[136:137] op_sel_hi:[1,0]
    v_pk_mul_f32 v[186:187], v[14:15], v[128:129] op_sel_hi:[1,0]
    v_lshlrev_b32 v14, 16, v34
    v_and_b32 v15, 0xffff0000, v34
    v_pk_mul_f32 v[180:181], v[14:15], v[136:137] op_sel_hi:[1,0]
    v_pk_mul_f32 v[188:189], v[14:15], v[128:129] op_sel_hi:[1,0]
    v_lshlrev_b32 v14, 16, v35
    v_and_b32 v15, 0xffff0000, v35
    v_pk_mul_f32 v[182:183], v[14:15], v[136:137] op_sel_hi:[1,0]
    v_pk_mul_f32 v[190:191], v[14:15], v[128:129] op_sel_hi:[1,0]
    v_lshlrev_b32 v14, 16, v36
    v_and_b32 v15, 0xffff0000, v36
    v_pk_fma_f32 v[176:177], v[14:15], v[136:137], v[176:177] op_sel:[0,1,0] op_sel_hi:[1,1,1]
    v_pk_fma_f32 v[184:185], v[14:15], v[128:129], v[184:185] op_sel:[0,1,0] op_sel_hi:[1,1,1]
    v_lshlrev_b32 v14, 16, v37
    v_and_b32 v15, 0xffff0000, v37
    v_pk_fma_f32 v[178:179], v[14:15], v[136:137], v[178:179] op_sel:[0,1,0] op_sel_hi:[1,1,1]
    v_pk_fma_f32 v[186:187], v[14:15], v[128:129], v[186:187] op_sel:[0,1,0] op_sel_hi:[1,1,1]
    v_lshlrev_b32 v14, 16, v38
    v_and_b32 v15, 0xffff0000, v38
    v_pk_fma_f32 v[180:181], v[14:15], v[136:137], v[180:181] op_sel:[0,1,0] op_sel_hi:[1,1,1]
    v_pk_fma_f32 v[188:189], v[14:15], v[128:129], v[188:189] op_sel:[0,1,0] op_sel_hi:[1,1,1]
    v_lshlrev_b32 v14, 16, v39
    v_and_b32 v15, 0xffff0000, v39
    v_pk_fma_f32 v[182:183], v[14:15], v[136:137], v[182:183] op_sel:[0,1,0] op_sel_hi:[1,1,1]
    v_pk_fma_f32 v[190:191], v[14:15], v[128:129], v[190:191] op_sel:[0,1,0] op_sel_hi:[1,1,1]
    v_lshlrev_b32 v14, 16, v40
    v_and_b32 v15, 0xffff0000, v40
    v_pk_fma_f32 v[176:177], v[14:15], v[138:139], v[176:177] op_sel:[0,0,0] op_sel_hi:[1,0,1]
    v_pk_fma_f32 v[184:185], v[14:15], v[130:131], v[184:185] op_sel:[0,0,0] op_sel_hi:[1,0,1]
    v_lshlrev_b32 v14, 16, v41
    v_and_b32 v15, 0xffff0000, v41
    v_pk_fma_f32 v[178:179], v[14:15], v[138:139], v[178:179] op_sel:[0,0,0] op_sel_hi:[1,0,1]
    v_pk_fma_f32 v[186:187], v[14:15], v[130:131], v[186:187] op_sel:[0,0,0] op_sel_hi:[1,0,1]
    v_lshlrev_b32 v14, 16, v42
    v_and_b32 v15, 0xffff0000, v42
    v_pk_fma_f32 v[180:181], v[14:15], v[138:139], v[180:181] op_sel:[0,0,0] op_sel_hi:[1,0,1]
    v_pk_fma_f32 v[188:189], v[14:15], v[130:131], v[188:189] op_sel:[0,0,0] op_sel_hi:[1,0,1]
    v_lshlrev_b32 v14, 16, v43
    v_and_b32 v15, 0xffff0000, v43
    v_pk_fma_f32 v[182:183], v[14:15], v[138:139], v[182:183] op_sel:[0,0,0] op_sel_hi:[1,0,1]
    v_pk_fma_f32 v[190:191], v[14:15], v[130:131], v[190:191] op_sel:[0,0,0] op_sel_hi:[1,0,1]
    v_lshlrev_b32 v14, 16, v44
    v_and_b32 v15, 0xffff0000, v44
    v_pk_fma_f32 v[176:177], v[14:15], v[138:139], v[176:177] op_sel:[0,1,0] op_sel_hi:[1,1,1]
    v_pk_fma_f32 v[184:185], v[14:15], v[130:131], v[184:185] op_sel:[0,1,0] op_sel_hi:[1,1,1]
    v_lshlrev_b32 v14, 16, v45
    v_and_b32 v15, 0xffff0000, v45
    v_pk_fma_f32 v[178:179], v[14:15], v[138:139], v[178:179] op_sel:[0,1,0] op_sel_hi:[1,1,1]
    v_pk_fma_f32 v[186:187], v[14:15], v[130:131], v[186:187] op_sel:[0,1,0] op_sel_hi:[1,1,1]
    v_lshlrev_b32 v14, 16, v46
    v_and_b32 v15, 0xffff0000, v46
    v_pk_fma_f32 v[180:181], v[14:15], v[138:139], v[180:181] op_sel:[0,1,0] op_sel_hi:[1,1,1]
    v_pk_fma_f32 v[188:189], v[14:15], v[130:131], v[188:189] op_sel:[0,1,0] op_sel_hi:[1,1,1]
    v_lshlrev_b32 v14, 16, v47
    v_and_b32 v15, 0xffff0000, v47
    v_pk_fma_f32 v[182:183], v[14:15], v[138:139], v[182:183] op_sel:[0,1,0] op_sel_hi:[1,1,1]
    v_pk_fma_f32 v[190:191], v[14:15], v[130:131], v[190:191] op_sel:[0,1,0] op_sel_hi:[1,1,1]
    v_lshlrev_b32 v14, 16, v48
    v_and_b32 v15, 0xffff0000, v48
    v_pk_fma_f32 v[176:177], v[14:15], v[140:141], v[176:177] op_sel:[0,0,0] op_sel_hi:[1,0,1]
    v_pk_fma_f32 v[184:185], v[14:15], v[132:133], v[184:185] op_sel:[0,0,0] op_sel_hi:[1,0,1]
    v_lshlrev_b32 v14, 16, v49
    v_and_b32 v15, 0xffff0000, v49
    v_pk_fma_f32 v[178:179], v[14:15], v[140:141], v[178:179] op_sel:[0,0,0] op_sel_hi:[1,0,1]
    v_pk_fma_f32 v[186:187], v[14:15], v[132:133], v[186:187] op_sel:[0,0,0] op_sel_hi:[1,0,1]
    v_lshlrev_b32 v14, 16, v50
    v_and_b32 v15, 0xffff0000, v50
    v_pk_fma_f32 v[180:181], v[14:15], v[140:141], v[180:181] op_sel:[0,0,0] op_sel_hi:[1,0,1]
    v_pk_fma_f32 v[188:189], v[14:15], v[132:133], v[188:189] op_sel:[0,0,0] op_sel_hi:[1,0,1]
    v_lshlrev_b32 v14, 16, v51
    v_and_b32 v15, 0xffff0000, v51
    v_pk_fma_f32 v[182:183], v[14:15], v[140:141], v[182:183] op_sel:[0,0,0] op_sel_hi:[1,0,1]
    v_pk_fma_f32 v[190:191], v[14:15], v[132:133], v[190:191] op_sel:[0,0,0] op_sel_hi:[1,0,1]
    v_lshlrev_b32 v14, 16, v52
    v_and_b32 v15, 0xffff0000, v52
    v_pk_fma_f32 v[176:177], v[14:15], v[140:141], v[176:177] op_sel:[0,1,0] op_sel_hi:[1,1,1]
    v_pk_fma_f32 v[184:185], v[14:15], v[132:133], v[184:185] op_sel:[0,1,0] op_sel_hi:[1,1,1]
    v_lshlrev_b32 v14, 16, v53
    v_and_b32 v15, 0xffff0000, v53
    v_pk_fma_f32 v[178:179], v[14:15], v[140:141], v[178:179] op_sel:[0,1,0] op_sel_hi:[1,1,1]
    v_pk_fma_f32 v[186:187], v[14:15], v[132:133], v[186:187] op_sel:[0,1,0] op_sel_hi:[1,1,1]
    v_lshlrev_b32 v14, 16, v54
    v_and_b32 v15, 0xffff0000, v54
    v_pk_fma_f32 v[180:181], v[14:15], v[140:141], v[180:181] op_sel:[0,1,0] op_sel_hi:[1,1,1]
    v_pk_fma_f32 v[188:189], v[14:15], v[132:133], v[188:189] op_sel:[0,1,0] op_sel_hi:[1,1,1]
    v_lshlrev_b32 v14, 16, v55
    v_and_b32 v15, 0xffff0000, v55
    v_pk_fma_f32 v[182:183], v[14:15], v[140:141], v[182:183] op_sel:[0,1,0] op_sel_hi:[1,1,1]
    v_pk_fma_f32 v[190:191], v[14:15], v[132:133], v[190:191] op_sel:[0,1,0] op_sel_hi:[1,1,1]
    v_lshlrev_b32 v14, 16, v56
    v_and_b32 v15, 0xffff0000, v56
    v_pk_fma_f32 v[176:177], v[14:15], v[142:143], v[176:177] op_sel:[0,0,0] op_sel_hi:[1,0,1]
    v_pk_fma_f32 v[184:185], v[14:15], v[134:135], v[184:185] op_sel:[0,0,0] op_sel_hi:[1,0,1]
    v_lshlrev_b32 v14, 16, v57
    v_and_b32 v15, 0xffff0000, v57
    v_pk_fma_f32 v[178:179], v[14:15], v[142:143], v[178:179] op_sel:[0,0,0] op_sel_hi:[1,0,1]
    v_pk_fma_f32 v[186:187], v[14:15], v[134:135], v[186:187] op_sel:[0,0,0] op_sel_hi:[1,0,1]
    v_lshlrev_b32 v14, 16, v58
    v_and_b32 v15, 0xffff0000, v58
    v_pk_fma_f32 v[180:181], v[14:15], v[142:143], v[180:181] op_sel:[0,0,0] op_sel_hi:[1,0,1]
    v_pk_fma_f32 v[188:189], v[14:15], v[134:135], v[188:189] op_sel:[0,0,0] op_sel_hi:[1,0,1]
    v_lshlrev_b32 v14, 16, v59
    v_and_b32 v15, 0xffff0000, v59
    v_pk_fma_f32 v[182:183], v[14:15], v[142:143], v[182:183] op_sel:[0,0,0] op_sel_hi:[1,0,1]
    v_pk_fma_f32 v[190:191], v[14:15], v[134:135], v[190:191] op_sel:[0,0,0] op_sel_hi:[1,0,1]
    v_lshlrev_b32 v14, 16, v60
    v_and_b32 v15, 0xffff0000, v60
    v_pk_fma_f32 v[176:177], v[14:15], v[142:143], v[176:177] op_sel:[0,1,0] op_sel_hi:[1,1,1]
    v_pk_fma_f32 v[184:185], v[14:15], v[134:135], v[184:185] op_sel:[0,1,0] op_sel_hi:[1,1,1]
    v_lshlrev_b32 v14, 16, v61
    v_and_b32 v15, 0xffff0000, v61
    v_pk_fma_f32 v[178:179], v[14:15], v[142:143], v[178:179] op_sel:[0,1,0] op_sel_hi:[1,1,1]
    v_pk_fma_f32 v[186:187], v[14:15], v[134:135], v[186:187] op_sel:[0,1,0] op_sel_hi:[1,1,1]
    v_lshlrev_b32 v14, 16, v62
    v_and_b32 v15, 0xffff0000, v62
    v_pk_fma_f32 v[180:181], v[14:15], v[142:143], v[180:181] op_sel:[0,1,0] op_sel_hi:[1,1,1]
    v_pk_fma_f32 v[188:189], v[14:15], v[134:135], v[188:189] op_sel:[0,1,0] op_sel_hi:[1,1,1]
    v_lshlrev_b32 v14, 16, v63
    v_and_b32 v15, 0xffff0000, v63
    v_pk_fma_f32 v[182:183], v[14:15], v[142:143], v[182:183] op_sel:[0,1,0] op_sel_hi:[1,1,1]
    v_pk_fma_f32 v[190:191], v[14:15], v[134:135], v[190:191] op_sel:[0,1,0] op_sel_hi:[1,1,1]
CV9:
    s_waitcnt vmcnt(15)
    v_mfma_f32_32x32x16_bf16 v[16:31], a[128:131], a[0:3], 0
    v_mfma_f32_32x32x16_bf16 v[32:47], a[132:135], a[0:3], 0
    s_waitcnt vmcnt(14)
    v_mfma_f32_32x32x16_bf16 v[48:63], a[128:131], a[4:7], 0
    v_mfma_f32_32x32x16_bf16 v[64:79], a[132:135], a[4:7], 0
    s_waitcnt vmcnt(13)
    v_mfma_f32_32x32x16_bf16 v[16:31], a[136:139], a[8:11], v[16:31]
    v_mfma_f32_32x32x16_bf16 v[32:47], a[140:143], a[8:11], v[32:47]
    s_waitcnt vmcnt(12)
    v_mfma_f32_32x32x16_bf16 v[48:63], a[136:139], a[12:15], v[48:63]
    v_mfma_f32_32x32x16_bf16 v[64:79], a[140:143], a[12:15], v[64:79]
    s_waitcnt vmcnt(11)
    v_mfma_f32_32x32x16_bf16 v[16:31], a[144:147], a[16:19], v[16:31]
    v_mfma_f32_32x32x16_bf16 v[32:47], a[148:151], a[16:19], v[32:47]
    s_waitcnt vmcnt(10)
    v_mfma_f32_32x32x16_bf16 v[48:63], a[144:147], a[20:23], v[48:63]
    v_mfma_f32_32x32x16_bf16 v[64:79], a[148:151], a[20:23], v[64:79]
    s_waitcnt vmcnt(9)
    v_mfma_f32_32x32x16_bf16 v[16:31], a[152:155], a[24:27], v[16:31]
    v_mfma_f32_32x32x16_bf16 v[32:47], a[156:159], a[24:27], v[32:47]
    s_waitcnt vmcnt(8)
    v_mfma_f32_32x32x16_bf16 v[48:63], a[152:155], a[28:31], v[48:63]
    v_mfma_f32_32x32x16_bf16 v[64:79], a[156:159], a[28:31], v[64:79]
    s_waitcnt vmcnt(7)
    v_mfma_f32_32x32x16_bf16 v[16:31], a[160:163], a[32:35], v[16:31]
    s_waitcnt vmcnt(5)
    v_mfma_f32_32x32x16_bf16 v[16:31], a[168:171], a[40:43], v[16:31]
    s_waitcnt vmcnt(3)
    v_mfma_f32_32x32x16_bf16 v[16:31], a[176:179], a[48:51], v[16:31]
    s_waitcnt vmcnt(1)
    v_mfma_f32_32x32x16_bf16 v[16:31], a[184:187], a[56:59], v[16:31]
    v_mfma_f32_32x32x16_bf16 v[32:47], a[164:167], a[32:35], v[32:47]
    s_nop 7
    v_mfma_f32_32x32x16_bf16 v[32:47], a[172:175], a[40:43], v[32:47]
    s_nop 1
    ds_write_b128 v7, v[16:19] offset:0
    ds_write_b128 v7, v[20:23] offset:1024
    v_mfma_f32_32x32x16_bf16 v[32:47], a[180:183], a[48:51], v[32:47]
    ds_write_b128 v7, v[24:27] offset:2048
    ds_write_b128 v7, v[28:31] offset:3072
    v_mfma_f32_32x32x16_bf16 v[32:47], a[188:191], a[56:59], v[32:47]
    v_mfma_f32_32x32x16_bf16 v[48:63], a[160:163], a[36:39], v[48:63]
    s_nop 7
    v_mfma_f32_32x32x16_bf16 v[48:63], a[168:171], a[44:47], v[48:63]
    s_nop 1
    ds_write_b128 v7, v[32:35] offset:4096
    ds_write_b128 v7, v[36:39] offset:5120
    v_mfma_f32_32x32x16_bf16 v[48:63], a[176:179], a[52:55], v[48:63]
    ds_write_b128 v7, v[40:43] offset:6144
    ds_write_b128 v7, v[44:47] offset:7168
    s_waitcnt vmcnt(0)
    v_mfma_f32_32x32x16_bf16 v[48:63], a[184:187], a[60:63], v[48:63]
    v_mfma_f32_32x32x16_bf16 v[64:79], a[164:167], a[36:39], v[64:79]
    s_nop 7
    v_mfma_f32_32x32x16_bf16 v[64:79], a[172:175], a[44:47], v[64:79]
    s_nop 1
    ds_write_b128 v7, v[48:51] offset:8192
    ds_write_b128 v7, v[52:55] offset:9216
    v_mfma_f32_32x32x16_bf16 v[64:79], a[180:183], a[52:55], v[64:79]
    ds_write_b128 v7, v[56:59] offset:10240
    ds_write_b128 v7, v[60:63] offset:11264
    v_mfma_f32_32x32x16_bf16 v[64:79], a[188:191], a[60:63], v[64:79]
    s_waitcnt lgkmcnt(0)
    s_barrier
    ds_read_b128 v[16:19], v4 offset:0
    ds_read_b128 v[20:23], v4 offset:1024
    ds_read_b128 v[24:27], v4 offset:2048
    ds_read_b128 v[28:31], v4 offset:3072
    ds_read_b128 v[32:35], v5 offset:4096
    ds_read_b128 v[36:39], v5 offset:5120
    ds_read_b128 v[40:43], v5 offset:6144
    ds_read_b128 v[44:47], v5 offset:7168
    ds_read_b128 v[48:51], v6 offset:8192
    ds_read_b128 v[52:55], v6 offset:9216
    ds_read_b128 v[56:59], v6 offset:10240
    ds_read_b128 v[60:63], v6 offset:11264
    s_waitcnt lgkmcnt(11)
    v_pk_add_f32 v[64:65], v[64:65], v[16:17]
    v_pk_add_f32 v[66:67], v[66:67], v[18:19]
    s_waitcnt lgkmcnt(10)
    v_pk_add_f32 v[68:69], v[68:69], v[20:21]
    v_pk_add_f32 v[70:71], v[70:71], v[22:23]
    s_waitcnt lgkmcnt(9)
    v_pk_add_f32 v[72:73], v[72:73], v[24:25]
    v_pk_add_f32 v[74:75], v[74:75], v[26:27]
    s_waitcnt lgkmcnt(8)
    v_pk_add_f32 v[76:77], v[76:77], v[28:29]
    v_pk_add_f32 v[78:79], v[78:79], v[30:31]
    s_waitcnt lgkmcnt(7)
    v_pk_add_f32 v[64:65], v[64:65], v[32:33]
    v_pk_add_f32 v[66:67], v[66:67], v[34:35]
    s_waitcnt lgkmcnt(6)
    v_pk_add_f32 v[68:69], v[68:69], v[36:37]
    v_pk_add_f32 v[70:71], v[70:71], v[38:39]
    s_waitcnt lgkmcnt(5)
    v_pk_add_f32 v[72:73], v[72:73], v[40:41]
    v_pk_add_f32 v[74:75], v[74:75], v[42:43]
    s_waitcnt lgkmcnt(4)
    v_pk_add_f32 v[76:77], v[76:77], v[44:45]
    v_pk_add_f32 v[78:79], v[78:79], v[46:47]
    s_waitcnt lgkmcnt(3)
    v_pk_add_f32 v[64:65], v[64:65], v[48:49]
    v_pk_add_f32 v[66:67], v[66:67], v[50:51]
    s_waitcnt lgkmcnt(2)
    v_pk_add_f32 v[68:69], v[68:69], v[52:53]
    v_pk_add_f32 v[70:71], v[70:71], v[54:55]
    s_waitcnt lgkmcnt(1)
    v_pk_add_f32 v[72:73], v[72:73], v[56:57]
    v_pk_add_f32 v[74:75], v[74:75], v[58:59]
    s_waitcnt lgkmcnt(0)
    v_pk_add_f32 v[76:77], v[76:77], v[60:61]
    v_pk_add_f32 v[78:79], v[78:79], v[62:63]
    s_lshl_b32 s28, s22, 15
    s_lshl_b32 s29, s23, 11
    s_add_u32 s28, s28, s29
    s_add_u32 s29, s28, 13631488
    v_pk_fma_f32 v[14:15], v[64:65], v[88:89], v[192:193]
    v_cvt_pk_bf16_f32 v16, v14, v15
    v_lshlrev_b32 v208, 16, v16
    v_and_b32 v209, 0xffff0000, v16
    v_pk_mul_f32 v[14:15], v[208:209], v[104:105]
    v_cvt_pk_bf16_f32 v24, v14, v15
    v_pk_fma_f32 v[14:15], v[66:67], v[90:91], v[194:195]
    v_cvt_pk_bf16_f32 v17, v14, v15
    v_lshlrev_b32 v210, 16, v17
    v_and_b32 v211, 0xffff0000, v17
    v_pk_mul_f32 v[14:15], v[210:211], v[106:107]
    v_cvt_pk_bf16_f32 v25, v14, v15
    v_pk_fma_f32 v[14:15], v[68:69], v[92:93], v[196:197]
    v_cvt_pk_bf16_f32 v18, v14, v15
    v_lshlrev_b32 v212, 16, v18
    v_and_b32 v213, 0xffff0000, v18
    v_pk_mul_f32 v[14:15], v[212:213], v[108:109]
    v_cvt_pk_bf16_f32 v26, v14, v15
    v_pk_fma_f32 v[14:15], v[70:71], v[94:95], v[198:199]
    v_cvt_pk_bf16_f32 v19, v14, v15
    v_lshlrev_b32 v214, 16, v19
    v_and_b32 v215, 0xffff0000, v19
    v_pk_mul_f32 v[14:15], v[214:215], v[110:111]
    v_cvt_pk_bf16_f32 v27, v14, v15
    buffer_store_dwordx4 v[24:27], v2, s[12:15], s29 offen offset:0 sc1
    v_pk_fma_f32 v[14:15], v[72:73], v[96:97], v[200:201]
    v_cvt_pk_bf16_f32 v20, v14, v15
    v_lshlrev_b32 v216, 16, v20
    v_and_b32 v217, 0xffff0000, v20
    v_pk_mul_f32 v[14:15], v[216:217], v[112:113]
    v_cvt_pk_bf16_f32 v28, v14, v15
    v_pk_fma_f32 v[14:15], v[74:75], v[98:99], v[202:203]
    v_cvt_pk_bf16_f32 v21, v14, v15
    v_lshlrev_b32 v218, 16, v21
    v_and_b32 v219, 0xffff0000, v21
    v_pk_mul_f32 v[14:15], v[218:219], v[114:115]
    v_cvt_pk_bf16_f32 v29, v14, v15
    v_pk_fma_f32 v[14:15], v[76:77], v[100:101], v[204:205]
    v_cvt_pk_bf16_f32 v22, v14, v15
    v_lshlrev_b32 v220, 16, v22
    v_and_b32 v221, 0xffff0000, v22
    v_pk_mul_f32 v[14:15], v[220:221], v[116:117]
    v_cvt_pk_bf16_f32 v30, v14, v15
    v_pk_fma_f32 v[14:15], v[78:79], v[102:103], v[206:207]
    v_cvt_pk_bf16_f32 v23, v14, v15
    v_lshlrev_b32 v222, 16, v23
    v_and_b32 v223, 0xffff0000, v23
    v_pk_mul_f32 v[14:15], v[222:223], v[118:119]
    v_cvt_pk_bf16_f32 v31, v14, v15
    buffer_store_dwordx4 v[28:31], v2, s[12:15], s29 offen offset:1024 sc1
    v_pk_add_f32 v[36:37], v[208:209], v[210:211]
    v_pk_mul_f32 v[38:39], v[208:209], v[208:209]
    v_pk_fma_f32 v[38:39], v[210:211], v[210:211], v[38:39]
    v_pk_add_f32 v[36:37], v[36:37], v[212:213]
    v_pk_fma_f32 v[38:39], v[212:213], v[212:213], v[38:39]
    v_pk_add_f32 v[36:37], v[36:37], v[214:215]
    v_pk_fma_f32 v[38:39], v[214:215], v[214:215], v[38:39]
    v_pk_add_f32 v[36:37], v[36:37], v[216:217]
    v_pk_fma_f32 v[38:39], v[216:217], v[216:217], v[38:39]
    v_pk_add_f32 v[36:37], v[36:37], v[218:219]
    v_pk_fma_f32 v[38:39], v[218:219], v[218:219], v[38:39]
    v_pk_add_f32 v[36:37], v[36:37], v[220:221]
    v_pk_fma_f32 v[38:39], v[220:221], v[220:221], v[38:39]
    v_pk_add_f32 v[36:37], v[36:37], v[222:223]
    v_pk_fma_f32 v[38:39], v[222:223], v[222:223], v[38:39]
    v_add_f32 v12, v36, v37
    v_add_f32 v13, v38, v39
    s_lshl_b32 s28, s22, 12
    s_lshl_b32 s29, s23, 8
    s_add_u32 s28, s28, s29
    s_add_u32 s28, s28, 65536
    v_and_b32 v3, 31, v1
    v_lshlrev_b32 v3, 3, v3
    v_mov_b32 v14, v12
    v_mov_b32 v15, v13
    s_nop 1
    v_permlane32_swap_b32 v12, v14
    v_permlane32_swap_b32 v13, v15
    v_add_f32 v12, v12, v14
    v_add_f32 v13, v13, v15
    buffer_store_dwordx2 v[12:13], v3, s[12:15], s28 offen sc1
    v_mov_b32 v112, v16
    v_mov_b32 v113, v17
    v_mov_b32 v114, v18
    v_mov_b32 v115, v19
    v_mov_b32 v116, v20
    v_mov_b32 v117, v21
    v_mov_b32 v118, v22
    v_mov_b32 v119, v23
    v_and_b32 v34, 15, v1
    v_min_u32 v34, 13, v34
    v_lshlrev_b32 v34, 3, v34
    v_add_u32 v34, s63, v34
    v_lshlrev_b32 v34, 3, v34
    s_mov_b32 s98, 598016
    buffer_load_dwordx2 v[32:33], v34, s[12:15], s98 offen sc1
    s_mul_i32 s38, s3, 229376
    s_mul_i32 s20, s4, 28672
    s_add_u32 s38, s38, s20
    s_add_u32 s38, s38, 15728640
    s_add_u32 s39, s38, 114688
    s_mul_i32 s36, s63, 229376
    s_add_u32 s36, s36, s20
    s_add_u32 s36, s36, 29884416
    s_add_u32 s37, s36, 114688
    s_bitcmp1_b32 s4, 1
    s_cselect_b32 s20, s38, s39
    s_cselect_b32 s39, s39, s38
    s_mov_b32 s38, s20
    s_bitcmp1_b32 s4, 0
    s_cselect_b32 s20, s36, s37
    s_cselect_b32 s37, s37, s36
    s_mov_b32 s36, s20
    s_waitcnt vmcnt(0)
    s_barrier
    s_cmp_lg_u32 s4, 0
    s_cbranch_scc1 PB13
    s_lshl_b32 s98, s35, 3
    s_add_u32 s98, s98, 600064
    v_mov_b32 v252, s96
    v_mov_b32 v253, s97
    v_mov_b32 v254, 0
    s_mov_b64 exec, 1
    buffer_store_dwordx2 v[252:253], v254, s[12:15], s98 offen sc1
    s_mov_b64 exec, -1
PB13:
    s_mov_b32 m0, s43
    s_nop 0
    buffer_load_dwordx4 v2, s[12:15], s42 offen offset:0 sc1 lds
    buffer_load_dwordx4 v2, s[12:15], s42 offen offset:1024 sc1 lds
    buffer_load_dwordx4 v2, s[12:15], s42 offen offset:2048 sc1 lds
    buffer_load_dwordx4 v2, s[12:15], s42 offen offset:3072 sc1 lds
    s_add_u32 s42, s42, 16384
    s_add_u32 s43, s43, 16384
    v_mov_b32 v120, v32
    v_mov_b32 v121, v33
    v_mov_b32 v122, v34
    s_cmp_lt_u32 s2, 112
    s_cbranch_scc1 CS9
    s_cmp_ge_u32 s2, 224
    s_cbranch_scc1 CS9
    s_lshl_b32 s57, s4, 11
    s_add_u32 s57, s57, 139264
    v_lshlrev_b32 v12, 5, v1
    v_add_u32 v12, s57, v12
    ds_write_b128 v12, v[176:179]
    ds_write_b128 v12, v[180:183] offset:16
    ds_write_b128 v12, v[184:187] offset:8192
    ds_write_b128 v12, v[188:191] offset:8208
    s_waitcnt lgkmcnt(0)
    s_barrier
    s_cmp_ge_u32 s4, 2
    s_cbranch_scc1 CS8
    v_and_b32 v13, 31, v1
    v_lshrrev_b32 v14, 5, v1
    v_lshlrev_b32 v12, 2, v13
    v_lshl_add_u32 v12, v14, 12, v12
    s_lshl_b32 s57, s4, 13
    s_add_u32 s57, s57, 139264
    v_add_u32 v12, s57, v12
    ds_read_b32 v16, v12 offset:0
    ds_read_b32 v17, v12 offset:128
    ds_read_b32 v18, v12 offset:256
    ds_read_b32 v19, v12 offset:384
    ds_read_b32 v20, v12 offset:512
    ds_read_b32 v21, v12 offset:640
    ds_read_b32 v22, v12 offset:768
    ds_read_b32 v23, v12 offset:896
    ds_read_b32 v24, v12 offset:1024
    ds_read_b32 v25, v12 offset:1152
    ds_read_b32 v26, v12 offset:1280
    ds_read_b32 v27, v12 offset:1408
    ds_read_b32 v28, v12 offset:1536
    ds_read_b32 v29, v12 offset:1664
    ds_read_b32 v30, v12 offset:1792
    ds_read_b32 v31, v12 offset:1920
    ds_read_b32 v32, v12 offset:2048
    ds_read_b32 v33, v12 offset:2176
    ds_read_b32 v34, v12 offset:2304
    ds_read_b32 v35, v12 offset:2432
    ds_read_b32 v36, v12 offset:2560
    ds_read_b32 v37, v12 offset:2688
    ds_read_b32 v38, v12 offset:2816
    ds_read_b32 v39, v12 offset:2944
    ds_read_b32 v40, v12 offset:3072
    ds_read_b32 v41, v12 offset:3200
    ds_read_b32 v42, v12 offset:3328
    ds_read_b32 v43, v12 offset:3456
    ds_read_b32 v44, v12 offset:3584
    ds_read_b32 v45, v12 offset:3712
    ds_read_b32 v46, v12 offset:3840
    ds_read_b32 v47, v12 offset:3968
    s_waitcnt lgkmcnt(0)
    v_add_f32 v16, v16, v32
    v_add_f32 v17, v17, v33
    v_add_f32 v18, v18, v34
    v_add_f32 v19, v19, v35
    v_add_f32 v20, v20, v36
    v_add_f32 v21, v21, v37
    v_add_f32 v22, v22, v38
    v_add_f32 v23, v23, v39
    v_add_f32 v24, v24, v40
    v_add_f32 v25, v25, v41
    v_add_f32 v26, v26, v42
    v_add_f32 v27, v27, v43
    v_add_f32 v28, v28, v44
    v_add_f32 v29, v29, v45
    v_add_f32 v30, v30, v46
    v_add_f32 v31, v31, v47
    v_add_f32 v16, v16, v24
    v_add_f32 v17, v17, v25
    v_add_f32 v18, v18, v26
    v_add_f32 v19, v19, v27
    v_add_f32 v20, v20, v28
    v_add_f32 v21, v21, v29
    v_add_f32 v22, v22, v30
    v_add_f32 v23, v23, v31
    v_add_f32 v16, v16, v20
    v_add_f32 v17, v17, v21
    v_add_f32 v18, v18, v22
    v_add_f32 v19, v19, v23
    v_add_f32 v16, v16, v18
    v_add_f32 v17, v17, v19
    v_add_f32 v16, v16, v17
    v_mov_b32 v17, v16
    s_nop 1
    v_permlane32_swap_b32 v16, v17
    v_add_f32 v16, v16, v17
    v_cvt_pk_bf16_f32 v18, v16, v16
    v_lshlrev_b32 v17, 16, v18
    v_sub_f32 v17, v16, v17
    v_cvt_pk_bf16_f32 v19, v17, 0
    v_lshrrev_b32 v14, 4, v13
    v_and_b32 v13, 15, v13
    v_lshlrev_b32 v13, 4, v13
    v_lshl_add_u32 v13, v14, 9, v13
    s_lshl_b32 s57, s44, 10
    s_lshr_b32 s58, s45, 2
    s_add_u32 s57, s57, s58
    s_xor_b32 s58, s4, 1
    s_lshl_b32 s58, s58, 3
    s_add_u32 s57, s57, s58
    s_add_u32 s57, s57, 786432
    buffer_store_dwordx2 v[18:19], v13, s[12:15], s57 offen sc1
CS8:
    s_barrier
CS9:
    v_cmp_ne_u64 vcc, s[96:97], v[120:121]
    s_cmp_eq_u64 vcc, 0
    s_cbranch_scc1 FBOK
    s_mov_b32 s99, 0
PL14:
    s_mov_b32 s98, 598016
    buffer_load_dwordx2 v[36:37], v122, s[12:15], s98 offen sc1
    s_add_u32 s99, s99, 1
    s_waitcnt vmcnt(0)
    v_cmp_ne_u64 vcc, s[96:97], v[36:37]
    s_cmp_eq_u64 vcc, 0
    s_cbranch_scc1 PD14
    s_sleep 2
    s_cmp_lt_u32 s99, 50000
    s_cbranch_scc1 PL14
PD14:
FBOK:
    s_and_b32 s27, s4, 1
    s_lshr_b32 s16, s5, 1
    s_lshl_b32 s16, s16, 2
    s_add_u32 s16, s16, s4
    s_lshl_b32 s17, s16, 15
    s_add_u32 s17, s17, 13631488
    s_mul_i32 s31, s4, 3072
    s_add_u32 s30, s41, s31
    s_add_u32 s30, s30, 131072
    s_add_u32 m0, s31, 131072
    s_nop 0
    buffer_load_dwordx4 v2, s[12:15], s30 offen offset:0 sc1 lds
    buffer_load_dwordx4 v2, s[12:15], s30 offen offset:1024 sc1 lds
    buffer_load_dwordx4 v2, s[12:15], s30 offen offset:2048 sc1 lds
    s_add_u32 s30, s30, 12288
    s_add_u32 m0, s31, 143360
    s_nop 0
    buffer_load_dwordx4 v2, s[12:15], s30 offen offset:0 sc1 lds
    buffer_load_dwordx4 v2, s[12:15], s30 offen offset:1024 sc1 lds
    buffer_load_dwordx4 v2, s[12:15], s30 offen offset:2048 sc1 lds
    s_add_u32 s30, s30, 12288
    s_mul_i32 s20, s40, 3584
    s_add_u32 s20, s20, 786432
    v_and_b32 v17, 31, v1
    v_lshlrev_b32 v17, 4, v17
    s_lshl_b32 s21, s16, 12
    s_add_u32 s21, s21, 65536
    v_lshlrev_b32 v4, 3, v1
    v_add_u32 v8, 65536, v2
    s_mul_i32 s33, s16, 114688
    s_mul_i32 s34, s40, 7168
    s_add_u32 s33, s33, s34
    s_add_u32 s33, s33, 15728640
    s_add_u32 s34, s33, 4096
    v_and_b32 v12, 15, v1
    v_lshlrev_b32 v12, 3, v12
    s_lshr_b32 s28, s5, 1
    s_lshl_b32 s28, s28, 7
    v_add_u32 v12, s28, v12
    v_and_b32 v13, 3, v1
    s_mul_i32 s28, s40, 7
    s_lshr_b32 s28, s28, 1
    v_add_u32 v13, s28, v13
    v_bfe_u32 v15, v1, 4, 1
    v_mul_u32_u24 v15, 56, v15
    v_add3_u32 v13, v13, v15, 56
    v_add_u32 v13, 56, v13
    v_lshlrev_b32 v13, 3, v13
    s_xor_b32 s28, s4, 3
    s_or_b32 s28, s28, s2
    s_cmp_lg_u32 s28, 0
    s_cbranch_scc1 NCE
    s_mov_b32 s99, 0
PL15:
    s_mov_b32 s98, 591872
    buffer_load_dwordx4 v[240:243], v2, s[12:15], s98 offen sc1
    s_mov_b32 s98, 592896
    buffer_load_dwordx4 v[244:247], v2, s[12:15], s98 offen sc1
    s_add_u32 s99, s99, 1
    s_waitcnt vmcnt(0)
    v_cmp_ne_u64 vcc, s[96:97], v[240:241]
    v_cmp_ne_u64 s[100:101], s[96:97], v[242:243]
    s_or_b64 vcc, vcc, s[100:101]
    v_cmp_ne_u64 s[100:101], s[96:97], v[244:245]
    s_or_b64 vcc, vcc, s[100:101]
    v_cmp_ne_u64 s[100:101], s[96:97], v[246:247]
    s_or_b64 vcc, vcc, s[100:101]
    s_cmp_eq_u64 vcc, 0
    s_cbranch_scc1 PD15
    s_sleep 2
    s_cmp_lt_u32 s99, 50000
    s_cbranch_scc1 PL15
PD15:
    v_mov_b32 v240, s96
    v_mov_b32 v241, s97
    v_mov_b32 v242, 0
    s_mov_b32 s28, 622592
    buffer_store_dwordx2 v[240:241], v242, s[12:15], s28 offen
NCE:
    s_cmp_lg_u32 s4, 0
    s_cbranch_scc1 PD16
    s_mov_b32 s99, 0
PL16:
    s_mov_b32 s98, 600064
    buffer_load_dwordx2 v[240:241], v12, s[12:15], s98 offen sc1
    s_add_u32 s99, s99, 1
    s_waitcnt vmcnt(0)
    v_cmp_ne_u64 vcc, s[96:97], v[240:241]
    s_cmp_eq_u64 vcc, 0
    s_cbranch_scc1 PD16
    s_sleep 2
    s_cmp_lt_u32 s99, 50000
    s_cbranch_scc1 PL16
PD16:
    s_waitcnt vmcnt(0)
    s_barrier
    s_cmp_lg_u32 s4, 0
    s_cbranch_scc1 PB17
    s_lshl_b32 s98, s2, 3
    s_add_u32 s98, s98, 606208
    v_mov_b32 v252, s96
    v_mov_b32 v253, s97
    v_mov_b32 v254, 0
    s_mov_b64 exec, 1
    buffer_store_dwordx2 v[252:253], v254, s[12:15], s98 offen sc1
    s_mov_b64 exec, -1
PB17:
    s_lshr_b32 s29, s5, 1
    v_and_b32 v12, 15, v1
    v_lshlrev_b32 v12, 3, v12
    s_lshr_b32 s28, s3, 1
    s_lshl_b32 s28, s28, 7
    v_add_u32 v12, s28, v12
    buffer_load_dwordx4 a[0:3], v2, s[12:15], s17 offen offset:0 sc1
    buffer_load_dwordx4 a[4:7], v2, s[12:15], s17 offen offset:1024 sc1
    buffer_load_dwordx4 a[8:11], v2, s[12:15], s17 offen offset:2048 sc1
    buffer_load_dwordx4 a[12:15], v2, s[12:15], s17 offen offset:3072 sc1
    s_add_u32 s17, s17, 4096
    buffer_load_dwordx4 a[16:19], v2, s[12:15], s17 offen offset:0 sc1
    buffer_load_dwordx4 a[20:23], v2, s[12:15], s17 offen offset:1024 sc1
    buffer_load_dwordx4 a[24:27], v2, s[12:15], s17 offen offset:2048 sc1
    buffer_load_dwordx4 a[28:31], v2, s[12:15], s17 offen offset:3072 sc1
    s_add_u32 s17, s17, 4096
    buffer_load_dwordx2 v[64:65], v4, s[12:15], s21 offen offset:0 sc1
    buffer_load_dwordx2 v[66:67], v4, s[12:15], s21 offen offset:512 sc1
    buffer_load_dwordx2 v[68:69], v4, s[12:15], s21 offen offset:1024 sc1
    buffer_load_dwordx2 v[70:71], v4, s[12:15], s21 offen offset:1536 sc1
    buffer_load_dwordx2 v[72:73], v4, s[12:15], s21 offen offset:2048 sc1
    buffer_load_dwordx2 v[74:75], v4, s[12:15], s21 offen offset:2560 sc1
    buffer_load_dwordx2 v[76:77], v4, s[12:15], s21 offen offset:3072 sc1
    buffer_load_dwordx2 v[78:79], v4, s[12:15], s21 offen offset:3584 sc1
    buffer_load_dwordx4 a[32:35], v2, s[12:15], s17 offen offset:0 sc1
    buffer_load_dwordx4 a[36:39], v2, s[12:15], s17 offen offset:1024 sc1
    buffer_load_dwordx4 a[40:43], v2, s[12:15], s17 offen offset:2048 sc1
    buffer_load_dwordx4 a[44:47], v2, s[12:15], s17 offen offset:3072 sc1
    s_add_u32 s17, s17, 4096
    ds_read_b128 v[32:35], v2 offset:0
    ds_read_b128 v[36:39], v2 offset:1024
    ds_read_b128 v[40:43], v2 offset:2048
    ds_read_b128 v[44:47], v2 offset:3072
    ds_read_b128 v[48:51], v2 offset:4096
    ds_read_b128 v[52:55], v2 offset:5120
    ds_read_b128 v[56:59], v2 offset:6144
    ds_read_b128 v[60:63], v2 offset:7168
    s_waitcnt vmcnt(19)
    s_waitcnt lgkmcnt(4)
    v_mfma_f32_32x32x16_bf16 v[128:143], v[32:35], a[0:3], 0
    ds_read_b128 v[96:99], v2 offset:8192
    v_mfma_f32_32x32x16_bf16 v[144:159], v[36:39], a[0:3], 0
    ds_read_b128 v[100:103], v2 offset:9216
    buffer_load_dwordx4 a[48:51], v2, s[12:15], s17 offen offset:0 sc1
    v_mfma_f32_32x32x16_bf16 v[160:175], v[40:43], a[0:3], 0
    ds_read_b128 v[104:107], v2 offset:10240
    v_mfma_f32_32x32x16_bf16 v[176:191], v[44:47], a[0:3], 0
    ds_read_b128 v[108:111], v2 offset:11264
    buffer_load_dwordx4 a[52:55], v2, s[12:15], s17 offen offset:1024 sc1
    s_waitcnt vmcnt(20)
    s_waitcnt lgkmcnt(4)
    v_mfma_f32_32x32x16_bf16 v[128:143], v[48:51], a[4:7], v[128:143]
    ds_read_b128 v[32:35], v2 offset:12288
    v_mfma_f32_32x32x16_bf16 v[144:159], v[52:55], a[4:7], v[144:159]
    ds_read_b128 v[36:39], v2 offset:13312
    buffer_load_dwordx4 a[56:59], v2, s[12:15], s17 offen offset:2048 sc1
    v_mfma_f32_32x32x16_bf16 v[160:175], v[56:59], a[4:7], v[160:175]
    ds_read_b128 v[40:43], v2 offset:14336
    v_mfma_f32_32x32x16_bf16 v[176:191], v[60:63], a[4:7], v[176:191]
    ds_read_b128 v[44:47], v2 offset:15360
    buffer_load_dwordx4 a[60:63], v2, s[12:15], s17 offen offset:3072 sc1
    s_add_u32 s17, s17, 4096
    s_barrier
    s_waitcnt vmcnt(21)
    s_waitcnt lgkmcnt(4)
    v_mfma_f32_32x32x16_bf16 v[128:143], v[96:99], a[8:11], v[128:143]
    ds_read_b128 v[48:51], v2 offset:16384
    v_mfma_f32_32x32x16_bf16 v[144:159], v[100:103], a[8:11], v[144:159]
    ds_read_b128 v[52:55], v2 offset:17408
    buffer_load_dwordx4 a[64:67], v2, s[12:15], s17 offen offset:0 sc1
    v_mfma_f32_32x32x16_bf16 v[160:175], v[104:107], a[8:11], v[160:175]
    ds_read_b128 v[56:59], v2 offset:18432
    v_mfma_f32_32x32x16_bf16 v[176:191], v[108:111], a[8:11], v[176:191]
    ds_read_b128 v[60:63], v2 offset:19456
    buffer_load_dwordx4 a[68:71], v2, s[12:15], s17 offen offset:1024 sc1
    s_waitcnt vmcnt(22)
    s_waitcnt lgkmcnt(4)
    v_mfma_f32_32x32x16_bf16 v[128:143], v[32:35], a[12:15], v[128:143]
    ds_read_b128 v[96:99], v2 offset:20480
    v_mfma_f32_32x32x16_bf16 v[144:159], v[36:39], a[12:15], v[144:159]
    ds_read_b128 v[100:103], v2 offset:21504
    buffer_load_dwordx4 a[72:75], v2, s[12:15], s17 offen offset:2048 sc1
    v_mfma_f32_32x32x16_bf16 v[160:175], v[40:43], a[12:15], v[160:175]
    ds_read_b128 v[104:107], v2 offset:22528
    v_mfma_f32_32x32x16_bf16 v[176:191], v[44:47], a[12:15], v[176:191]
    ds_read_b128 v[108:111], v2 offset:23552
    buffer_load_dwordx4 a[76:79], v2, s[12:15], s17 offen offset:3072 sc1
    s_add_u32 s17, s17, 4096
    s_waitcnt vmcnt(23)
    s_waitcnt lgkmcnt(4)
    v_mfma_f32_32x32x16_bf16 v[128:143], v[48:51], a[16:19], v[128:143]
    ds_read_b128 v[32:35], v2 offset:24576
    v_mfma_f32_32x32x16_bf16 v[144:159], v[52:55], a[16:19], v[144:159]
    ds_read_b128 v[36:39], v2 offset:25600
    buffer_load_dwordx4 a[80:83], v2, s[12:15], s17 offen offset:0 sc1
    v_mfma_f32_32x32x16_bf16 v[160:175], v[56:59], a[16:19], v[160:175]
    ds_read_b128 v[40:43], v2 offset:26624
    v_mfma_f32_32x32x16_bf16 v[176:191], v[60:63], a[16:19], v[176:191]
    ds_read_b128 v[44:47], v2 offset:27648
    buffer_load_dwordx4 a[84:87], v2, s[12:15], s17 offen offset:1024 sc1
    s_waitcnt vmcnt(24)
    s_waitcnt lgkmcnt(4)
    v_mfma_f32_32x32x16_bf16 v[128:143], v[96:99], a[20:23], v[128:143]
    ds_read_b128 v[48:51], v2 offset:28672
    v_mfma_f32_32x32x16_bf16 v[144:159], v[100:103], a[20:23], v[144:159]
    ds_read_b128 v[52:55], v2 offset:29696
    buffer_load_dwordx4 a[88:91], v2, s[12:15], s17 offen offset:2048 sc1
    v_mfma_f32_32x32x16_bf16 v[160:175], v[104:107], a[20:23], v[160:175]
    ds_read_b128 v[56:59], v2 offset:30720
    v_mfma_f32_32x32x16_bf16 v[176:191], v[108:111], a[20:23], v[176:191]
    ds_read_b128 v[60:63], v2 offset:31744
    buffer_load_dwordx4 a[92:95], v2, s[12:15], s17 offen offset:3072 sc1
    s_add_u32 s17, s17, 4096
    s_barrier
    s_waitcnt vmcnt(25)
    s_waitcnt lgkmcnt(4)
    v_mfma_f32_32x32x16_bf16 v[128:143], v[32:35], a[24:27], v[128:143]
    ds_read_b128 v[96:99], v2 offset:32768
    v_mfma_f32_32x32x16_bf16 v[144:159], v[36:39], a[24:27], v[144:159]
    ds_read_b128 v[100:103], v2 offset:33792
    buffer_load_dwordx4 a[96:99], v2, s[12:15], s17 offen offset:0 sc1
    v_mfma_f32_32x32x16_bf16 v[160:175], v[40:43], a[24:27], v[160:175]
    ds_read_b128 v[104:107], v2 offset:34816
    v_mfma_f32_32x32x16_bf16 v[176:191], v[44:47], a[24:27], v[176:191]
    ds_read_b128 v[108:111], v2 offset:35840
    buffer_load_dwordx4 a[100:103], v2, s[12:15], s17 offen offset:1024 sc1
    s_waitcnt vmcnt(26)
    s_waitcnt lgkmcnt(4)
    v_mfma_f32_32x32x16_bf16 v[128:143], v[48:51], a[28:31], v[128:143]
    ds_read_b128 v[32:35], v2 offset:36864
    v_mfma_f32_32x32x16_bf16 v[144:159], v[52:55], a[28:31], v[144:159]
    ds_read_b128 v[36:39], v2 offset:37888
    buffer_load_dwordx4 a[104:107], v2, s[12:15], s17 offen offset:2048 sc1
    v_mfma_f32_32x32x16_bf16 v[160:175], v[56:59], a[28:31], v[160:175]
    ds_read_b128 v[40:43], v2 offset:38912
    v_mfma_f32_32x32x16_bf16 v[176:191], v[60:63], a[28:31], v[176:191]
    ds_read_b128 v[44:47], v2 offset:39936
    buffer_load_dwordx4 a[108:111], v2, s[12:15], s17 offen offset:3072 sc1
    s_add_u32 s17, s17, 4096
    s_waitcnt vmcnt(19)
    s_waitcnt lgkmcnt(4)
    v_mfma_f32_32x32x16_bf16 v[128:143], v[96:99], a[32:35], v[128:143]
    ds_read_b128 v[48:51], v2 offset:40960
    v_mfma_f32_32x32x16_bf16 v[144:159], v[100:103], a[32:35], v[144:159]
    ds_read_b128 v[52:55], v2 offset:41984
    buffer_load_dwordx4 a[112:115], v2, s[12:15], s17 offen offset:0 sc1
    v_mfma_f32_32x32x16_bf16 v[160:175], v[104:107], a[32:35], v[160:175]
    ds_read_b128 v[56:59], v2 offset:43008
    v_mfma_f32_32x32x16_bf16 v[176:191], v[108:111], a[32:35], v[176:191]
    ds_read_b128 v[60:63], v2 offset:44032
    buffer_load_dwordx4 a[116:119], v2, s[12:15], s17 offen offset:1024 sc1
    s_waitcnt vmcnt(20)
    s_waitcnt lgkmcnt(4)
    v_mfma_f32_32x32x16_bf16 v[128:143], v[32:35], a[36:39], v[128:143]
    ds_read_b128 v[96:99], v2 offset:45056
    v_mfma_f32_32x32x16_bf16 v[144:159], v[36:39], a[36:39], v[144:159]
    ds_read_b128 v[100:103], v2 offset:46080
    buffer_load_dwordx4 a[120:123], v2, s[12:15], s17 offen offset:2048 sc1
    v_mfma_f32_32x32x16_bf16 v[160:175], v[40:43], a[36:39], v[160:175]
    ds_read_b128 v[104:107], v2 offset:47104
    v_mfma_f32_32x32x16_bf16 v[176:191], v[44:47], a[36:39], v[176:191]
    ds_read_b128 v[108:111], v2 offset:48128
    buffer_load_dwordx4 a[124:127], v2, s[12:15], s17 offen offset:3072 sc1
    s_add_u32 s17, s17, 4096
    s_barrier
    s_waitcnt vmcnt(21)
    s_waitcnt lgkmcnt(4)
    v_mfma_f32_32x32x16_bf16 v[128:143], v[48:51], a[40:43], v[128:143]
    ds_read_b128 v[32:35], v2 offset:49152
    v_mfma_f32_32x32x16_bf16 v[144:159], v[52:55], a[40:43], v[144:159]
    ds_read_b128 v[36:39], v2 offset:50176
    s_add_u32 m0, s31, 0
    s_nop 0
    buffer_load_dwordx4 v2, s[12:15], s30 offen offset:0 sc1 lds
    v_mfma_f32_32x32x16_bf16 v[160:175], v[56:59], a[40:43], v[160:175]
    ds_read_b128 v[40:43], v2 offset:51200
    v_mfma_f32_32x32x16_bf16 v[176:191], v[60:63], a[40:43], v[176:191]
    ds_read_b128 v[44:47], v2 offset:52224
    buffer_load_dwordx4 v2, s[12:15], s30 offen offset:1024 sc1 lds
    s_waitcnt vmcnt(22)
    s_waitcnt lgkmcnt(4)
    v_mfma_f32_32x32x16_bf16 v[128:143], v[96:99], a[44:47], v[128:143]
    ds_read_b128 v[48:51], v2 offset:53248
    v_add_f32 v64, v64, v66
    v_add_f32 v65, v65, v67
    v_add_f32 v64, v64, v68
    v_add_f32 v65, v65, v69
    v_add_f32 v64, v64, v70
    v_mfma_f32_32x32x16_bf16 v[144:159], v[100:103], a[44:47], v[144:159]
    ds_read_b128 v[52:55], v2 offset:54272
    buffer_load_dwordx4 v2, s[12:15], s30 offen offset:2048 sc1 lds
    s_add_u32 s30, s30, 12288
    v_add_f32 v65, v65, v71
    v_add_f32 v64, v64, v72
    v_add_f32 v65, v65, v73
    v_add_f32 v64, v64, v74
    v_mfma_f32_32x32x16_bf16 v[160:175], v[104:107], a[44:47], v[160:175]
    ds_read_b128 v[56:59], v2 offset:55296
    v_add_f32 v65, v65, v75
    v_add_f32 v64, v64, v76
    v_add_f32 v65, v65, v77
    v_add_f32 v64, v64, v78
    v_add_f32 v65, v65, v79
    v_mov_b32 v66, v64
    v_mfma_f32_32x32x16_bf16 v[176:191], v[108:111], a[44:47], v[176:191]
    ds_read_b128 v[60:63], v2 offset:56320
    buffer_load_dwordx4 a[128:131], v2, s[12:15], s36 offen offset:0 sc1
    v_mov_b32 v67, v65
    s_nop 1
    v_permlane32_swap_b32 v64, v66
    v_permlane32_swap_b32 v65, v67
    s_waitcnt vmcnt(23)
    s_waitcnt lgkmcnt(4)
    v_mfma_f32_32x32x16_bf16 v[128:143], v[32:35], a[48:51], v[128:143]
    ds_read_b128 v[96:99], v2 offset:57344
    v_add_f32 v64, v64, v66
    v_add_f32 v65, v65, v67
    v_mul_f32 v18, 989855744, v64
    v_mul_f32 v65, 989855744, v65
    v_fma_f32 v65, -v18, v18, v65
    v_max_f32 v65, 0, v65
    v_mfma_f32_32x32x16_bf16 v[144:159], v[36:39], a[48:51], v[144:159]
    ds_read_b128 v[100:103], v2 offset:58368
    s_add_u32 m0, s31, 16384
    s_nop 0
    buffer_load_dwordx4 v2, s[12:15], s30 offen offset:0 sc1 lds
    v_add_f32 v65, 925353388, v65
    v_rsq_f32 v20, v65
    s_nop 0
    v_mul_f32 v19, v20, v65
    v_mfma_f32_32x32x16_bf16 v[160:175], v[40:43], a[48:51], v[160:175]
    ds_read_b128 v[104:107], v2 offset:59392
    v_mul_f32 v20, 3216550459, v20
    v_sub_f32 v18, 0, v18
    v_cmp_gt_u32 vcc, 32, v1
    v_cvt_pk_bf16_f32 v25, v19, 0
    v_lshlrev_b32 v21, 16, v25
    v_sub_f32 v21, v19, v21
    v_mfma_f32_32x32x16_bf16 v[176:191], v[44:47], a[48:51], v[176:191]
    ds_read_b128 v[108:111], v2 offset:60416
    buffer_load_dwordx4 v2, s[12:15], s30 offen offset:1024 sc1 lds
    v_cvt_pk_bf16_f32 v24, v19, v21
    v_cndmask_b32 v24, 0, v24, vcc
    v_cndmask_b32 v25, 0, v25, vcc
    v_cvt_pk_bf16_f32 v27, v18, 0
    s_waitcnt vmcnt(24)
    s_waitcnt lgkmcnt(4)
    v_mfma_f32_32x32x16_bf16 v[128:143], v[48:51], a[52:55], v[128:143]
    ds_read_b128 v[32:35], v2 offset:61440
    v_lshlrev_b32 v21, 16, v27
    v_sub_f32 v21, v18, v21
    v_cvt_pk_bf16_f32 v26, v18, v21
    v_cndmask_b32 v26, 0, v26, vcc
    v_cndmask_b32 v27, 0, v27, vcc
    v_mfma_f32_32x32x16_bf16 v[144:159], v[52:55], a[52:55], v[144:159]
    ds_read_b128 v[36:39], v2 offset:62464
    buffer_load_dwordx4 v2, s[12:15], s30 offen offset:2048 sc1 lds
    s_add_u32 s30, s30, 12288
    v_mfma_f32_32x32x16_bf16 v[160:175], v[56:59], a[52:55], v[160:175]
    ds_read_b128 v[40:43], v2 offset:63488
    v_mfma_f32_32x32x16_bf16 v[176:191], v[60:63], a[52:55], v[176:191]
    ds_read_b128 v[44:47], v2 offset:64512
    buffer_load_dwordx4 a[132:135], v2, s[12:15], s37 offen offset:0 sc1
    s_barrier
    s_waitcnt vmcnt(25)
    s_waitcnt lgkmcnt(4)
    v_mfma_f32_32x32x16_bf16 v[128:143], v[96:99], a[56:59], v[128:143]
    ds_read_b128 v[48:51], v8 offset:0
    v_mfma_f32_32x32x16_bf16 v[144:159], v[100:103], a[56:59], v[144:159]
    ds_read_b128 v[52:55], v8 offset:1024
    buffer_load_dwordx4 a[136:139], v2, s[12:15], s36 offen offset:1024 sc1
    v_mfma_f32_32x32x16_bf16 v[160:175], v[104:107], a[56:59], v[160:175]
    ds_read_b128 v[56:59], v8 offset:2048
    v_mfma_f32_32x32x16_bf16 v[176:191], v[108:111], a[56:59], v[176:191]
    ds_read_b128 v[60:63], v8 offset:3072
    buffer_load_dwordx4 a[140:143], v2, s[12:15], s37 offen offset:1024 sc1
    s_waitcnt vmcnt(26)
    s_waitcnt lgkmcnt(4)
    v_mfma_f32_32x32x16_bf16 v[128:143], v[32:35], a[60:63], v[128:143]
    ds_read_b128 v[96:99], v8 offset:4096
    v_mfma_f32_32x32x16_bf16 v[144:159], v[36:39], a[60:63], v[144:159]
    ds_read_b128 v[100:103], v8 offset:5120
    buffer_load_dwordx4 a[144:147], v2, s[12:15], s36 offen offset:2048 sc1
    v_mfma_f32_32x32x16_bf16 v[160:175], v[40:43], a[60:63], v[160:175]
    ds_read_b128 v[104:107], v8 offset:6144
    v_mfma_f32_32x32x16_bf16 v[176:191], v[44:47], a[60:63], v[176:191]
    ds_read_b128 v[108:111], v8 offset:7168
    buffer_load_dwordx4 a[148:151], v2, s[12:15], s37 offen offset:2048 sc1
    s_waitcnt vmcnt(27)
    s_waitcnt lgkmcnt(4)
    v_mfma_f32_32x32x16_bf16 v[128:143], v[48:51], a[64:67], v[128:143]
    ds_read_b128 v[32:35], v8 offset:8192
    v_mfma_f32_32x32x16_bf16 v[144:159], v[52:55], a[64:67], v[144:159]
    ds_read_b128 v[36:39], v8 offset:9216
    s_add_u32 m0, s31, 32768
    s_nop 0
    buffer_load_dwordx4 v2, s[12:15], s30 offen offset:0 sc1 lds
    v_mfma_f32_32x32x16_bf16 v[160:175], v[56:59], a[64:67], v[160:175]
    ds_read_b128 v[40:43], v8 offset:10240
    v_mfma_f32_32x32x16_bf16 v[176:191], v[60:63], a[64:67], v[176:191]
    ds_read_b128 v[44:47], v8 offset:11264
    buffer_load_dwordx4 v2, s[12:15], s30 offen offset:1024 sc1 lds
    s_waitcnt vmcnt(28)
    s_waitcnt lgkmcnt(4)
    v_mfma_f32_32x32x16_bf16 v[128:143], v[96:99], a[68:71], v[128:143]
    ds_read_b128 v[48:51], v8 offset:12288
    v_mfma_f32_32x32x16_bf16 v[144:159], v[100:103], a[68:71], v[144:159]
    ds_read_b128 v[52:55], v8 offset:13312
    buffer_load_dwordx4 v2, s[12:15], s30 offen offset:2048 sc1 lds
    s_add_u32 s30, s30, 12288
    v_mfma_f32_32x32x16_bf16 v[160:175], v[104:107], a[68:71], v[160:175]
    ds_read_b128 v[56:59], v8 offset:14336
    v_mfma_f32_32x32x16_bf16 v[176:191], v[108:111], a[68:71], v[176:191]
    ds_read_b128 v[60:63], v8 offset:15360
    buffer_load_dwordx4 a[152:155], v2, s[12:15], s36 offen offset:3072 sc1
    s_add_u32 s36, s36, 7168
    s_barrier
    s_waitcnt vmcnt(29)
    s_waitcnt lgkmcnt(4)
    v_mfma_f32_32x32x16_bf16 v[128:143], v[32:35], a[72:75], v[128:143]
    ds_read_b128 v[96:99], v8 offset:16384
    v_mfma_f32_32x32x16_bf16 v[144:159], v[36:39], a[72:75], v[144:159]
    ds_read_b128 v[100:103], v8 offset:17408
    buffer_load_dwordx4 a[156:159], v2, s[12:15], s37 offen offset:3072 sc1
    s_add_u32 s37, s37, 7168
    v_mfma_f32_32x32x16_bf16 v[160:175], v[40:43], a[72:75], v[160:175]
    ds_read_b128 v[104:107], v8 offset:18432
    v_mfma_f32_32x32x16_bf16 v[176:191], v[44:47], a[72:75], v[176:191]
    ds_read_b128 v[108:111], v8 offset:19456
    buffer_load_dwordx4 a[160:163], v2, s[12:15], s36 offen offset:0 sc1
    s_mov_b32 s98, 606208
    buffer_load_dwordx2 v[14:15], v13, s[12:15], s98 offen sc1
    s_waitcnt vmcnt(31)
    s_waitcnt lgkmcnt(4)
    v_mfma_f32_32x32x16_bf16 v[128:143], v[48:51], a[76:79], v[128:143]
    ds_read_b128 v[32:35], v8 offset:20480
    v_mfma_f32_32x32x16_bf16 v[144:159], v[52:55], a[76:79], v[144:159]
    ds_read_b128 v[36:39], v8 offset:21504
    buffer_load_dwordx4 a[164:167], v2, s[12:15], s37 offen offset:0 sc1
    v_mfma_f32_32x32x16_bf16 v[160:175], v[56:59], a[76:79], v[160:175]
    ds_read_b128 v[40:43], v8 offset:22528
    v_mfma_f32_32x32x16_bf16 v[176:191], v[60:63], a[76:79], v[176:191]
    ds_read_b128 v[44:47], v8 offset:23552
    buffer_load_dwordx4 a[168:171], v2, s[12:15], s36 offen offset:1024 sc1
    s_waitcnt vmcnt(32)
    s_waitcnt lgkmcnt(4)
    v_mfma_f32_32x32x16_bf16 v[128:143], v[96:99], a[80:83], v[128:143]
    ds_read_b128 v[48:51], v8 offset:24576
    v_mfma_f32_32x32x16_bf16 v[144:159], v[100:103], a[80:83], v[144:159]
    ds_read_b128 v[52:55], v8 offset:25600
    s_add_u32 m0, s31, 49152
    s_nop 0
    buffer_load_dwordx4 v2, s[12:15], s30 offen offset:0 sc1 lds
    v_mfma_f32_32x32x16_bf16 v[160:175], v[104:107], a[80:83], v[160:175]
    ds_read_b128 v[56:59], v8 offset:26624
    v_mfma_f32_32x32x16_bf16 v[176:191], v[108:111], a[80:83], v[176:191]
    ds_read_b128 v[60:63], v8 offset:27648
    buffer_load_dwordx4 v2, s[12:15], s30 offen offset:1024 sc1 lds
    s_waitcnt vmcnt(33)
    s_waitcnt lgkmcnt(4)
    v_mfma_f32_32x32x16_bf16 v[128:143], v[32:35], a[84:87], v[128:143]
    ds_read_b128 v[96:99], v8 offset:28672
    v_mfma_f32_32x32x16_bf16 v[144:159], v[36:39], a[84:87], v[144:159]
    ds_read_b128 v[100:103], v8 offset:29696
    buffer_load_dwordx4 v2, s[12:15], s30 offen offset:2048 sc1 lds
    s_add_u32 s30, s30, 12288
    v_mfma_f32_32x32x16_bf16 v[160:175], v[40:43], a[84:87], v[160:175]
    ds_read_b128 v[104:107], v8 offset:30720
    v_mfma_f32_32x32x16_bf16 v[176:191], v[44:47], a[84:87], v[176:191]
    ds_read_b128 v[108:111], v8 offset:31744
    buffer_load_dwordx4 a[172:175], v2, s[12:15], s37 offen offset:1024 sc1
    s_barrier
    s_waitcnt vmcnt(34)
    s_waitcnt lgkmcnt(4)
    v_mfma_f32_32x32x16_bf16 v[128:143], v[48:51], a[88:91], v[128:143]
    ds_read_b128 v[32:35], v8 offset:32768
    v_mfma_f32_32x32x16_bf16 v[144:159], v[52:55], a[88:91], v[144:159]
    ds_read_b128 v[36:39], v8 offset:33792
    buffer_load_dwordx4 a[176:179], v2, s[12:15], s36 offen offset:2048 sc1
    v_mfma_f32_32x32x16_bf16 v[160:175], v[56:59], a[88:91], v[160:175]
    ds_read_b128 v[40:43], v8 offset:34816
    v_mfma_f32_32x32x16_bf16 v[176:191], v[60:63], a[88:91], v[176:191]
    ds_read_b128 v[44:47], v8 offset:35840
    buffer_load_dwordx4 a[180:183], v2, s[12:15], s37 offen offset:2048 sc1
    s_waitcnt vmcnt(35)
    s_waitcnt lgkmcnt(4)
    v_mfma_f32_32x32x16_bf16 v[128:143], v[96:99], a[92:95], v[128:143]
    ds_read_b128 v[48:51], v8 offset:36864
    v_mfma_f32_32x32x16_bf16 v[144:159], v[100:103], a[92:95], v[144:159]
    ds_read_b128 v[52:55], v8 offset:37888
    buffer_load_dwordx4 a[184:187], v2, s[12:15], s36 offen offset:3072 sc1
    s_add_u32 s36, s36, 7168
    v_mfma_f32_32x32x16_bf16 v[160:175], v[104:107], a[92:95], v[160:175]
    ds_read_b128 v[56:59], v8 offset:38912
    v_mfma_f32_32x32x16_bf16 v[176:191], v[108:111], a[92:95], v[176:191]
    ds_read_b128 v[60:63], v8 offset:39936
    buffer_load_dwordx4 a[188:191], v2, s[12:15], s37 offen offset:3072 sc1
    s_add_u32 s37, s37, 7168
    s_waitcnt vmcnt(36)
    s_waitcnt lgkmcnt(4)
    v_mfma_f32_32x32x16_bf16 v[128:143], v[32:35], a[96:99], v[128:143]
    ds_read_b128 v[96:99], v8 offset:40960
    v_mfma_f32_32x32x16_bf16 v[144:159], v[36:39], a[96:99], v[144:159]
    ds_read_b128 v[100:103], v8 offset:41984
    s_add_u32 m0, s31, 65536
    s_nop 0
    buffer_load_dwordx4 v2, s[12:15], s30 offen offset:0 sc1 lds
    v_mfma_f32_32x32x16_bf16 v[160:175], v[40:43], a[96:99], v[160:175]
    ds_read_b128 v[104:107], v8 offset:43008
    v_mfma_f32_32x32x16_bf16 v[176:191], v[44:47], a[96:99], v[176:191]
    ds_read_b128 v[108:111], v8 offset:44032
    buffer_load_dwordx4 v2, s[12:15], s30 offen offset:1024 sc1 lds
    s_waitcnt vmcnt(12)
    v_cmp_ne_u64 vcc, s[96:97], v[14:15]
    s_cmp_eq_u64 vcc, 0
    s_cbranch_scc1 FCOK
    s_mov_b32 s99, 0
PL18:
    s_mov_b32 s98, 606208
    buffer_load_dwordx2 v[240:241], v13, s[12:15], s98 offen sc1
    s_add_u32 s99, s99, 1
    s_waitcnt vmcnt(0)
    v_cmp_ne_u64 vcc, s[96:97], v[240:241]
    s_cmp_eq_u64 vcc, 0
    s_cbranch_scc1 PD18
    s_sleep 2
    s_cmp_lt_u32 s99, 50000
    s_cbranch_scc1 PL18
PD18:
FCOK:
    buffer_load_dwordx4 v[68:71], v17, s[12:15], s20 offen offset:0 sc1
    buffer_load_dwordx4 v[72:75], v17, s[12:15], s20 offen offset:512 sc1
    buffer_load_dwordx4 v[76:79], v17, s[12:15], s20 offen offset:1024 sc1
    buffer_load_dwordx4 v[80:83], v17, s[12:15], s20 offen offset:1536 sc1
    buffer_load_dwordx4 v[84:87], v17, s[12:15], s20 offen offset:2048 sc1
    buffer_load_dwordx4 v[88:91], v17, s[12:15], s20 offen offset:2560 sc1
    buffer_load_dwordx4 v[92:95], v17, s[12:15], s20 offen offset:3072 sc1
    s_waitcnt lgkmcnt(4)
    v_mfma_f32_32x32x16_bf16 v[128:143], v[48:51], a[100:103], v[128:143]
    ds_read_b128 v[32:35], v8 offset:45056
    v_mfma_f32_32x32x16_bf16 v[144:159], v[52:55], a[100:103], v[144:159]
    ds_read_b128 v[36:39], v8 offset:46080
    buffer_load_dwordx4 v2, s[12:15], s30 offen offset:2048 sc1 lds
    s_add_u32 s30, s30, 12288
    v_mfma_f32_32x32x16_bf16 v[160:175], v[56:59], a[100:103], v[160:175]
    ds_read_b128 v[40:43], v8 offset:47104
    v_mfma_f32_32x32x16_bf16 v[176:191], v[60:63], a[100:103], v[176:191]
    ds_read_b128 v[44:47], v8 offset:48128
    buffer_load_dwordx4 a[192:195], v2, s[12:15], s36 offen offset:0 sc1
    s_barrier
    s_waitcnt lgkmcnt(4)
    v_mfma_f32_32x32x16_bf16 v[128:143], v[96:99], a[104:107], v[128:143]
    ds_read_b128 v[48:51], v8 offset:49152
    v_mfma_f32_32x32x16_bf16 v[144:159], v[100:103], a[104:107], v[144:159]
    ds_read_b128 v[52:55], v8 offset:50176
    buffer_load_dwordx4 a[196:199], v2, s[12:15], s37 offen offset:0 sc1
    v_mfma_f32_32x32x16_bf16 v[160:175], v[104:107], a[104:107], v[160:175]
    ds_read_b128 v[56:59], v8 offset:51200
    v_mfma_f32_32x32x16_bf16 v[176:191], v[108:111], a[104:107], v[176:191]
    ds_read_b128 v[60:63], v8 offset:52224
    buffer_load_dwordx4 a[200:203], v2, s[12:15], s36 offen offset:1024 sc1
    s_waitcnt lgkmcnt(4)
    v_mfma_f32_32x32x16_bf16 v[128:143], v[32:35], a[108:111], v[128:143]
    ds_read_b128 v[96:99], v8 offset:53248
    v_mfma_f32_32x32x16_bf16 v[144:159], v[36:39], a[108:111], v[144:159]
    ds_read_b128 v[100:103], v8 offset:54272
    buffer_load_dwordx4 a[204:207], v2, s[12:15], s37 offen offset:1024 sc1
    v_mfma_f32_32x32x16_bf16 v[160:175], v[40:43], a[108:111], v[160:175]
    ds_read_b128 v[104:107], v8 offset:55296
    v_mfma_f32_32x32x16_bf16 v[176:191], v[44:47], a[108:111], v[176:191]
    ds_read_b128 v[108:111], v8 offset:56320
    buffer_load_dwordx4 a[208:211], v2, s[12:15], s36 offen offset:2048 sc1
    s_waitcnt lgkmcnt(4)
    v_mfma_f32_32x32x16_bf16 v[128:143], v[48:51], a[112:115], v[128:143]
    ds_read_b128 v[32:35], v8 offset:57344
    v_mfma_f32_32x32x16_bf16 v[144:159], v[52:55], a[112:115], v[144:159]
    ds_read_b128 v[36:39], v8 offset:58368
    s_add_u32 m0, s31, 81920
    s_nop 0
    buffer_load_dwordx4 v2, s[12:15], s30 offen offset:0 sc1 lds
    v_mfma_f32_32x32x16_bf16 v[160:175], v[56:59], a[112:115], v[160:175]
    ds_read_b128 v[40:43], v8 offset:59392
    v_mfma_f32_32x32x16_bf16 v[176:191], v[60:63], a[112:115], v[176:191]
    ds_read_b128 v[44:47], v8 offset:60416
    buffer_load_dwordx4 v2, s[12:15], s30 offen offset:1024 sc1 lds
    s_waitcnt lgkmcnt(4)
    v_mfma_f32_32x32x16_bf16 v[128:143], v[96:99], a[116:119], v[128:143]
    ds_read_b128 v[48:51], v8 offset:61440
    v_mfma_f32_32x32x16_bf16 v[144:159], v[100:103], a[116:119], v[144:159]
    ds_read_b128 v[52:55], v8 offset:62464
    buffer_load_dwordx4 v2, s[12:15], s30 offen offset:2048 sc1 lds
    s_add_u32 s30, s30, 12288
    v_mfma_f32_32x32x16_bf16 v[160:175], v[104:107], a[116:119], v[160:175]
    ds_read_b128 v[56:59], v8 offset:63488
    v_mfma_f32_32x32x16_bf16 v[176:191], v[108:111], a[116:119], v[176:191]
    ds_read_b128 v[60:63], v8 offset:64512
    buffer_load_dwordx4 a[212:215], v2, s[12:15], s37 offen offset:2048 sc1
    s_barrier
    s_waitcnt lgkmcnt(4)
    v_mfma_f32_32x32x16_bf16 v[128:143], v[32:35], a[120:123], v[128:143]
    v_add_u32 v16, 131072, v2
    ds_read_b128 v[96:99], v16 offset:0
    v_mfma_f32_32x32x16_bf16 v[144:159], v[36:39], a[120:123], v[144:159]
    ds_read_b128 v[100:103], v16 offset:1024
    buffer_load_dwordx4 a[216:219], v2, s[12:15], s36 offen offset:3072 sc1
    s_add_u32 s36, s36, 7168
    v_mfma_f32_32x32x16_bf16 v[160:175], v[40:43], a[120:123], v[160:175]
    ds_read_b128 v[104:107], v16 offset:2048
    v_mfma_f32_32x32x16_bf16 v[176:191], v[44:47], a[120:123], v[176:191]
    buffer_load_dwordx4 a[220:223], v2, s[12:15], s37 offen offset:3072 sc1
    s_add_u32 s37, s37, 7168
    s_waitcnt lgkmcnt(3)
    v_mfma_f32_32x32x16_bf16 v[128:143], v[48:51], a[124:127], v[128:143]
    ds_read_b128 v[32:35], v16 offset:3072
    v_mfma_f32_32x32x16_bf16 v[144:159], v[52:55], a[124:127], v[144:159]
    ds_read_b128 v[36:39], v16 offset:4096
    buffer_load_dwordx4 a[224:227], v2, s[12:15], s36 offen offset:0 sc1
    v_mfma_f32_32x32x16_bf16 v[160:175], v[56:59], a[124:127], v[160:175]
    ds_read_b128 v[40:43], v16 offset:5120
    v_mfma_f32_32x32x16_bf16 v[176:191], v[60:63], a[124:127], v[176:191]
    buffer_load_dwordx4 a[228:231], v2, s[12:15], s37 offen offset:0 sc1
    s_waitcnt vmcnt(14)
    v_mfma_f32_32x32x16_bf16 v[128:143], v[68:71], v[24:27], v[128:143]
    v_mfma_f32_32x32x16_bf16 v[144:159], v[72:75], v[24:27], v[144:159]
    v_mfma_f32_32x32x16_bf16 v[160:175], v[76:79], v[24:27], v[160:175]
    v_mfma_f32_32x32x16_bf16 v[176:191], v[80:83], v[24:27], v[176:191]
    v_mfma_f32_32x32x16_bf16 v[192:207], v[84:87], v[24:27], 0
    v_mfma_f32_32x32x16_bf16 v[208:223], v[88:91], v[24:27], 0
    v_mfma_f32_32x32x16_bf16 v[224:239], v[92:95], v[24:27], 0
    s_waitcnt lgkmcnt(3)
    v_mfma_f32_32x32x16_bf16 v[192:207], v[96:99], a[0:3], v[192:207]
    ds_read_b128 v[48:51], v16 offset:6144
    v_mfma_f32_32x32x16_bf16 v[208:223], v[100:103], a[0:3], v[208:223]
    ds_read_b128 v[52:55], v16 offset:7168
    buffer_load_dwordx4 a[232:235], v2, s[12:15], s36 offen offset:1024 sc1
    v_mfma_f32_32x32x16_bf16 v[224:239], v[104:107], a[0:3], v[224:239]
    ds_read_b128 v[56:59], v16 offset:8192
    s_waitcnt lgkmcnt(3)
    v_mfma_f32_32x32x16_bf16 v[192:207], v[32:35], a[4:7], v[192:207]
    ds_read_b128 v[96:99], v16 offset:9216
    buffer_load_dwordx4 a[236:239], v2, s[12:15], s37 offen offset:1024 sc1
    v_mul_f32 v128, v128, v20
    v_mul_f32 v129, v129, v20
    v_mul_f32 v130, v130, v20
    v_mul_f32 v131, v131, v20
    v_mfma_f32_32x32x16_bf16 v[208:223], v[36:39], a[4:7], v[208:223]
    ds_read_b128 v[100:103], v16 offset:10240
    v_mul_f32 v132, v132, v20
    v_mul_f32 v133, v133, v20
    v_mul_f32 v134, v134, v20
    v_mul_f32 v135, v135, v20
    v_exp_f32 v128, v128
    v_mfma_f32_32x32x16_bf16 v[224:239], v[40:43], a[4:7], v[224:239]
    ds_read_b128 v[104:107], v16 offset:11264
    buffer_load_dwordx4 a[240:243], v2, s[12:15], s36 offen offset:2048 sc1
    v_exp_f32 v129, v129
    v_exp_f32 v130, v130
    s_barrier
    s_waitcnt lgkmcnt(3)
    v_mfma_f32_32x32x16_bf16 v[192:207], v[48:51], a[8:11], v[192:207]
    v_add_u32 v16, 143360, v2
    ds_read_b128 v[32:35], v16 offset:0
    v_exp_f32 v131, v131
    v_exp_f32 v132, v132
    v_mfma_f32_32x32x16_bf16 v[208:223], v[52:55], a[8:11], v[208:223]
    ds_read_b128 v[36:39], v16 offset:1024
    buffer_load_dwordx4 a[244:247], v2, s[12:15], s37 offen offset:2048 sc1
    v_exp_f32 v133, v133
    v_exp_f32 v134, v134
    v_mfma_f32_32x32x16_bf16 v[224:239], v[56:59], a[8:11], v[224:239]
    ds_read_b128 v[40:43], v16 offset:2048
    v_exp_f32 v135, v135
    v_fma_f32 v128, v128, v19, v19
    v_fma_f32 v129, v129, v19, v19
    v_fma_f32 v130, v130, v19, v19
    v_fma_f32 v131, v131, v19, v19
    s_waitcnt lgkmcnt(3)
    v_mfma_f32_32x32x16_bf16 v[192:207], v[96:99], a[12:15], v[192:207]
    ds_read_b128 v[48:51], v16 offset:3072
    buffer_load_dwordx4 a[248:251], v2, s[12:15], s36 offen offset:3072 sc1
    s_add_u32 s36, s36, 4294949888
    v_fma_f32 v132, v132, v19, v19
    v_fma_f32 v133, v133, v19, v19
    v_fma_f32 v134, v134, v19, v19
    v_fma_f32 v135, v135, v19, v19
    v_mfma_f32_32x32x16_bf16 v[208:223], v[100:103], a[12:15], v[208:223]
    ds_read_b128 v[52:55], v16 offset:4096
    v_rcp_f32 v128, v128
    v_rcp_f32 v129, v129
    v_rcp_f32 v130, v130
    v_mfma_f32_32x32x16_bf16 v[224:239], v[104:107], a[12:15], v[224:239]
    ds_read_b128 v[56:59], v16 offset:5120
    buffer_load_dwordx4 a[252:255], v2, s[12:15], s37 offen offset:3072 sc1
    s_add_u32 s37, s37, 4294949888
    v_rcp_f32 v131, v131
    v_rcp_f32 v132, v132
    s_waitcnt lgkmcnt(3)
    v_mfma_f32_32x32x16_bf16 v[192:207], v[32:35], a[16:19], v[192:207]
    ds_read_b128 v[96:99], v16 offset:6144
    v_rcp_f32 v133, v133
    v_rcp_f32 v134, v134
    v_rcp_f32 v135, v135
    v_mfma_f32_32x32x16_bf16 v[208:223], v[36:39], a[16:19], v[208:223]
    ds_read_b128 v[100:103], v16 offset:7168
    buffer_load_dwordx4 a[0:3], v2, s[12:15], s36 offen offset:0 sc1
    v_mul_f32 v128, v128, v136
    v_mul_f32 v129, v129, v137
    v_mul_f32 v130, v130, v138
    v_mul_f32 v131, v131, v139
    v_mfma_f32_32x32x16_bf16 v[224:239], v[40:43], a[16:19], v[224:239]
    ds_read_b128 v[104:107], v16 offset:8192
    v_mul_f32 v132, v132, v140
    v_mul_f32 v133, v133, v141
    v_mul_f32 v134, v134, v142
    v_mul_f32 v135, v135, v143
    v_cvt_pk_bf16_f32 v136, v128, v129
    v_cvt_pk_bf16_f32 v137, v130, v131
    s_waitcnt lgkmcnt(3)
    v_mfma_f32_32x32x16_bf16 v[192:207], v[48:51], a[20:23], v[192:207]
    ds_read_b128 v[32:35], v16 offset:9216
    buffer_load_dwordx4 a[4:7], v2, s[12:15], s37 offen offset:0 sc1
    v_cvt_pk_bf16_f32 v138, v132, v133
    v_cvt_pk_bf16_f32 v139, v134, v135
    buffer_store_dwordx4 v[136:139], v2, s[12:15], s33 offen offset:0 sc1
    v_mfma_f32_32x32x16_bf16 v[208:223], v[52:55], a[20:23], v[208:223]
    ds_read_b128 v[36:39], v16 offset:10240
    v_mul_f32 v144, v144, v20
    v_mul_f32 v145, v145, v20
    v_mul_f32 v146, v146, v20
    v_mul_f32 v147, v147, v20
    v_mul_f32 v148, v148, v20
    v_mul_f32 v149, v149, v20
    v_mfma_f32_32x32x16_bf16 v[224:239], v[56:59], a[20:23], v[224:239]
    ds_read_b128 v[40:43], v16 offset:11264
    buffer_load_dwordx4 a[8:11], v2, s[12:15], s36 offen offset:1024 sc1
    v_mul_f32 v150, v150, v20
    v_mul_f32 v151, v151, v20
    v_exp_f32 v144, v144
    s_barrier
    s_waitcnt lgkmcnt(3)
    v_mfma_f32_32x32x16_bf16 v[192:207], v[96:99], a[24:27], v[192:207]
    v_add_u32 v16, 0, v2
    ds_read_b128 v[48:51], v16 offset:0
    v_exp_f32 v145, v145
    v_exp_f32 v146, v146
    v_mfma_f32_32x32x16_bf16 v[208:223], v[100:103], a[24:27], v[208:223]
    ds_read_b128 v[52:55], v16 offset:1024
    buffer_load_dwordx4 a[12:15], v2, s[12:15], s37 offen offset:1024 sc1
    v_exp_f32 v147, v147
    v_exp_f32 v148, v148
    v_mfma_f32_32x32x16_bf16 v[224:239], v[104:107], a[24:27], v[224:239]
    ds_read_b128 v[56:59], v16 offset:2048
    v_exp_f32 v149, v149
    v_exp_f32 v150, v150
    v_exp_f32 v151, v151
    s_waitcnt lgkmcnt(3)
    v_mfma_f32_32x32x16_bf16 v[192:207], v[32:35], a[28:31], v[192:207]
    ds_read_b128 v[96:99], v16 offset:3072
    buffer_load_dwordx4 a[16:19], v2, s[12:15], s36 offen offset:2048 sc1
    s_add_u32 s36, s36, 7168
    v_fma_f32 v144, v144, v19, v19
    v_fma_f32 v145, v145, v19, v19
    v_fma_f32 v146, v146, v19, v19
    v_fma_f32 v147, v147, v19, v19
    v_mfma_f32_32x32x16_bf16 v[208:223], v[36:39], a[28:31], v[208:223]
    ds_read_b128 v[100:103], v16 offset:4096
    v_fma_f32 v148, v148, v19, v19
    v_fma_f32 v149, v149, v19, v19
    v_fma_f32 v150, v150, v19, v19
    v_fma_f32 v151, v151, v19, v19
    v_rcp_f32 v144, v144
    v_mfma_f32_32x32x16_bf16 v[224:239], v[40:43], a[28:31], v[224:239]
    ds_read_b128 v[104:107], v16 offset:5120
    buffer_load_dwordx4 a[20:23], v2, s[12:15], s37 offen offset:2048 sc1
    s_add_u32 s37, s37, 7168
    v_rcp_f32 v145, v145
    v_rcp_f32 v146, v146
    s_waitcnt lgkmcnt(3)
    v_mfma_f32_32x32x16_bf16 v[192:207], v[48:51], a[32:35], v[192:207]
    ds_read_b128 v[32:35], v16 offset:6144
    v_rcp_f32 v147, v147
    v_rcp_f32 v148, v148
    v_rcp_f32 v149, v149
    v_mfma_f32_32x32x16_bf16 v[208:223], v[52:55], a[32:35], v[208:223]
    ds_read_b128 v[36:39], v16 offset:7168
    buffer_load_dwordx4 a[24:27], v2, s[12:15], s36 offen offset:0 sc1
    v_rcp_f32 v150, v150
    v_rcp_f32 v151, v151
    v_mfma_f32_32x32x16_bf16 v[224:239], v[56:59], a[32:35], v[224:239]
    ds_read_b128 v[40:43], v16 offset:8192
    v_mul_f32 v144, v144, v152
    v_mul_f32 v145, v145, v153
    v_mul_f32 v146, v146, v154
    v_mul_f32 v147, v147, v155
    v_mul_f32 v148, v148, v156
    v_mul_f32 v149, v149, v157
    s_waitcnt lgkmcnt(3)
    v_mfma_f32_32x32x16_bf16 v[192:207], v[96:99], a[36:39], v[192:207]
    ds_read_b128 v[48:51], v16 offset:9216
    buffer_load_dwordx4 a[28:31], v2, s[12:15], s37 offen offset:0 sc1
    v_mul_f32 v150, v150, v158
    v_mul_f32 v151, v151, v159
    v_cvt_pk_bf16_f32 v152, v144, v145
    v_cvt_pk_bf16_f32 v153, v146, v147
    v_mfma_f32_32x32x16_bf16 v[208:223], v[100:103], a[36:39], v[208:223]
    ds_read_b128 v[52:55], v16 offset:10240
    v_cvt_pk_bf16_f32 v154, v148, v149
    v_cvt_pk_bf16_f32 v155, v150, v151
    buffer_store_dwordx4 v[152:155], v2, s[12:15], s33 offen offset:1024 sc1
    v_mul_f32 v160, v160, v20
    v_mul_f32 v161, v161, v20
    v_mfma_f32_32x32x16_bf16 v[224:239], v[104:107], a[36:39], v[224:239]
    ds_read_b128 v[56:59], v16 offset:11264
    v_mul_f32 v162, v162, v20
    v_mul_f32 v163, v163, v20
    v_mul_f32 v164, v164, v20
    v_mul_f32 v165, v165, v20
    v_mul_f32 v166, v166, v20
    v_mul_f32 v167, v167, v20
    s_barrier
    s_waitcnt lgkmcnt(3)
    v_mfma_f32_32x32x16_bf16 v[192:207], v[32:35], a[40:43], v[192:207]
    v_add_u32 v16, 16384, v2
    ds_read_b128 v[96:99], v16 offset:0
    v_exp_f32 v160, v160
    v_exp_f32 v161, v161
    v_mfma_f32_32x32x16_bf16 v[208:223], v[36:39], a[40:43], v[208:223]
    ds_read_b128 v[100:103], v16 offset:1024
    buffer_load_dwordx4 a[32:35], v2, s[12:15], s36 offen offset:1024 sc1
    v_exp_f32 v162, v162
    v_exp_f32 v163, v163
    v_mfma_f32_32x32x16_bf16 v[224:239], v[40:43], a[40:43], v[224:239]
    ds_read_b128 v[104:107], v16 offset:2048
    v_exp_f32 v164, v164
    v_exp_f32 v165, v165
    v_exp_f32 v166, v166
    s_waitcnt lgkmcnt(3)
    v_mfma_f32_32x32x16_bf16 v[192:207], v[48:51], a[44:47], v[192:207]
    ds_read_b128 v[32:35], v16 offset:3072
    buffer_load_dwordx4 a[36:39], v2, s[12:15], s37 offen offset:1024 sc1
    v_exp_f32 v167, v167
    v_fma_f32 v160, v160, v19, v19
    v_fma_f32 v161, v161, v19, v19
    v_mfma_f32_32x32x16_bf16 v[208:223], v[52:55], a[44:47], v[208:223]
    ds_read_b128 v[36:39], v16 offset:4096
    v_fma_f32 v162, v162, v19, v19
    v_fma_f32 v163, v163, v19, v19
    v_fma_f32 v164, v164, v19, v19
    v_fma_f32 v165, v165, v19, v19
    v_fma_f32 v166, v166, v19, v19
    v_fma_f32 v167, v167, v19, v19
    v_mfma_f32_32x32x16_bf16 v[224:239], v[56:59], a[44:47], v[224:239]
    ds_read_b128 v[40:43], v16 offset:5120
    v_rcp_f32 v160, v160
    v_rcp_f32 v161, v161
    v_rcp_f32 v162, v162
    s_waitcnt lgkmcnt(3)
    v_mfma_f32_32x32x16_bf16 v[192:207], v[96:99], a[48:51], v[192:207]
    ds_read_b128 v[48:51], v16 offset:6144
    v_rcp_f32 v163, v163
    v_rcp_f32 v164, v164
    v_rcp_f32 v165, v165
    v_mfma_f32_32x32x16_bf16 v[208:223], v[100:103], a[48:51], v[208:223]
    ds_read_b128 v[52:55], v16 offset:7168
    buffer_load_dwordx4 a[40:43], v2, s[12:15], s36 offen offset:2048 sc1
    s_add_u32 s36, s36, 7168
    v_rcp_f32 v166, v166
    v_rcp_f32 v167, v167
    v_mfma_f32_32x32x16_bf16 v[224:239], v[104:107], a[48:51], v[224:239]
    ds_read_b128 v[56:59], v16 offset:8192
    v_mul_f32 v160, v160, v168
    v_mul_f32 v161, v161, v169
    v_mul_f32 v162, v162, v170
    v_mul_f32 v163, v163, v171
    v_mul_f32 v164, v164, v172
    v_mul_f32 v165, v165, v173
    s_waitcnt lgkmcnt(3)
    v_mfma_f32_32x32x16_bf16 v[192:207], v[32:35], a[52:55], v[192:207]
    ds_read_b128 v[96:99], v16 offset:9216
    buffer_load_dwordx4 a[44:47], v2, s[12:15], s37 offen offset:2048 sc1
    s_add_u32 s37, s37, 7168
    v_mul_f32 v166, v166, v174
    v_mul_f32 v167, v167, v175
    v_cvt_pk_bf16_f32 v168, v160, v161
    v_cvt_pk_bf16_f32 v169, v162, v163
    v_mfma_f32_32x32x16_bf16 v[208:223], v[36:39], a[52:55], v[208:223]
    ds_read_b128 v[100:103], v16 offset:10240
    v_cvt_pk_bf16_f32 v170, v164, v165
    v_cvt_pk_bf16_f32 v171, v166, v167
    buffer_store_dwordx4 v[168:171], v2, s[12:15], s33 offen offset:2048 sc1
    v_mul_f32 v176, v176, v20
    v_mul_f32 v177, v177, v20
    v_mfma_f32_32x32x16_bf16 v[224:239], v[40:43], a[52:55], v[224:239]
    ds_read_b128 v[104:107], v16 offset:11264
    v_mul_f32 v178, v178, v20
    v_mul_f32 v179, v179, v20
    v_mul_f32 v180, v180, v20
    v_mul_f32 v181, v181, v20
    v_mul_f32 v182, v182, v20
    v_mul_f32 v183, v183, v20
    s_barrier
    s_waitcnt lgkmcnt(3)
    v_mfma_f32_32x32x16_bf16 v[192:207], v[48:51], a[56:59], v[192:207]
    v_add_u32 v16, 32768, v2
    ds_read_b128 v[32:35], v16 offset:0
    v_exp_f32 v176, v176
    v_exp_f32 v177, v177
    v_mfma_f32_32x32x16_bf16 v[208:223], v[52:55], a[56:59], v[208:223]
    ds_read_b128 v[36:39], v16 offset:1024
    buffer_load_dwordx4 a[48:51], v2, s[12:15], s36 offen offset:0 sc1
    v_exp_f32 v178, v178
    v_exp_f32 v179, v179
    v_mfma_f32_32x32x16_bf16 v[224:239], v[56:59], a[56:59], v[224:239]
    ds_read_b128 v[40:43], v16 offset:2048
    v_exp_f32 v180, v180
    v_exp_f32 v181, v181
    v_exp_f32 v182, v182
    s_waitcnt lgkmcnt(3)
    v_mfma_f32_32x32x16_bf16 v[192:207], v[96:99], a[60:63], v[192:207]
    ds_read_b128 v[48:51], v16 offset:3072
    buffer_load_dwordx4 a[52:55], v2, s[12:15], s37 offen offset:0 sc1
    v_exp_f32 v183, v183
    v_fma_f32 v176, v176, v19, v19
    v_fma_f32 v177, v177, v19, v19
    v_mfma_f32_32x32x16_bf16 v[208:223], v[100:103], a[60:63], v[208:223]
    ds_read_b128 v[52:55], v16 offset:4096
    v_fma_f32 v178, v178, v19, v19
    v_fma_f32 v179, v179, v19, v19
    v_fma_f32 v180, v180, v19, v19
    v_fma_f32 v181, v181, v19, v19
    v_fma_f32 v182, v182, v19, v19
    v_fma_f32 v183, v183, v19, v19
    v_mfma_f32_32x32x16_bf16 v[224:239], v[104:107], a[60:63], v[224:239]
    ds_read_b128 v[56:59], v16 offset:5120
    v_rcp_f32 v176, v176
    v_rcp_f32 v177, v177
    v_rcp_f32 v178, v178
    s_waitcnt lgkmcnt(3)
    v_mfma_f32_32x32x16_bf16 v[192:207], v[32:35], a[64:67], v[192:207]
    ds_read_b128 v[96:99], v16 offset:6144
    v_rcp_f32 v179, v179
    v_rcp_f32 v180, v180
    v_rcp_f32 v181, v181
    v_mfma_f32_32x32x16_bf16 v[208:223], v[36:39], a[64:67], v[208:223]
    ds_read_b128 v[100:103], v16 offset:7168
    buffer_load_dwordx4 a[56:59], v2, s[12:15], s36 offen offset:1024 sc1
    v_rcp_f32 v182, v182
    v_rcp_f32 v183, v183
    v_mfma_f32_32x32x16_bf16 v[224:239], v[40:43], a[64:67], v[224:239]
    ds_read_b128 v[104:107], v16 offset:8192
    v_mul_f32 v176, v176, v184
    v_mul_f32 v177, v177, v185
    v_mul_f32 v178, v178, v186
    v_mul_f32 v179, v179, v187
    v_mul_f32 v180, v180, v188
    v_mul_f32 v181, v181, v189
    s_waitcnt lgkmcnt(3)
    v_mfma_f32_32x32x16_bf16 v[192:207], v[48:51], a[68:71], v[192:207]
    ds_read_b128 v[32:35], v16 offset:9216
    buffer_load_dwordx4 a[60:63], v2, s[12:15], s37 offen offset:1024 sc1
    v_mul_f32 v182, v182, v190
    v_mul_f32 v183, v183, v191
    v_cvt_pk_bf16_f32 v184, v176, v177
    v_cvt_pk_bf16_f32 v185, v178, v179
    v_mfma_f32_32x32x16_bf16 v[208:223], v[52:55], a[68:71], v[208:223]
    ds_read_b128 v[36:39], v16 offset:10240
    v_cvt_pk_bf16_f32 v186, v180, v181
    v_cvt_pk_bf16_f32 v187, v182, v183
    buffer_store_dwordx4 v[184:187], v2, s[12:15], s33 offen offset:3072 sc1
    v_mfma_f32_32x32x16_bf16 v[224:239], v[56:59], a[68:71], v[224:239]
    ds_read_b128 v[40:43], v16 offset:11264
    s_barrier
    s_waitcnt lgkmcnt(3)
    v_mfma_f32_32x32x16_bf16 v[192:207], v[96:99], a[72:75], v[192:207]
    v_add_u32 v16, 49152, v2
    ds_read_b128 v[48:51], v16 offset:0
    v_mfma_f32_32x32x16_bf16 v[208:223], v[100:103], a[72:75], v[208:223]
    ds_read_b128 v[52:55], v16 offset:1024
    buffer_load_dwordx4 a[64:67], v2, s[12:15], s36 offen offset:2048 sc1
    s_add_u32 s36, s36, 7168
    v_mfma_f32_32x32x16_bf16 v[224:239], v[104:107], a[72:75], v[224:239]
    ds_read_b128 v[56:59], v16 offset:2048
    s_waitcnt lgkmcnt(3)
    v_mfma_f32_32x32x16_bf16 v[192:207], v[32:35], a[76:79], v[192:207]
    ds_read_b128 v[96:99], v16 offset:3072
    buffer_load_dwordx4 a[68:71], v2, s[12:15], s37 offen offset:2048 sc1
    s_add_u32 s37, s37, 7168
    v_mfma_f32_32x32x16_bf16 v[208:223], v[36:39], a[76:79], v[208:223]
    ds_read_b128 v[100:103], v16 offset:4096
    v_mfma_f32_32x32x16_bf16 v[224:239], v[40:43], a[76:79], v[224:239]
    ds_read_b128 v[104:107], v16 offset:5120
    s_waitcnt lgkmcnt(3)
    v_mfma_f32_32x32x16_bf16 v[192:207], v[48:51], a[80:83], v[192:207]
    ds_read_b128 v[32:35], v16 offset:6144
    v_mfma_f32_32x32x16_bf16 v[208:223], v[52:55], a[80:83], v[208:223]
    ds_read_b128 v[36:39], v16 offset:7168
    buffer_load_dwordx4 a[72:75], v2, s[12:15], s36 offen offset:0 sc1
    v_mfma_f32_32x32x16_bf16 v[224:239], v[56:59], a[80:83], v[224:239]
    ds_read_b128 v[40:43], v16 offset:8192
    s_waitcnt lgkmcnt(3)
    v_mfma_f32_32x32x16_bf16 v[192:207], v[96:99], a[84:87], v[192:207]
    ds_read_b128 v[48:51], v16 offset:9216
    buffer_load_dwordx4 a[76:79], v2, s[12:15], s37 offen offset:0 sc1
    v_mfma_f32_32x32x16_bf16 v[208:223], v[100:103], a[84:87], v[208:223]
    ds_read_b128 v[52:55], v16 offset:10240
    v_mfma_f32_32x32x16_bf16 v[224:239], v[104:107], a[84:87], v[224:239]
    ds_read_b128 v[56:59], v16 offset:11264
    s_waitcnt vmcnt(43)
    s_waitcnt vmcnt(4)
    s_barrier
    s_cmp_lg_u32 s4, 0
    s_cbranch_scc1 PB19
    s_lshl_b32 s98, s7, 3
    s_add_u32 s98, s98, 604160
    v_mov_b32 v252, s96
    v_mov_b32 v253, s97
    v_mov_b32 v254, 0
    s_mov_b64 exec, 1
    buffer_store_dwordx2 v[252:253], v254, s[12:15], s98 offen sc1
    s_mov_b64 exec, -1
PB19:
    s_waitcnt lgkmcnt(3)
    v_mfma_f32_32x32x16_bf16 v[192:207], v[32:35], a[88:91], v[192:207]
    v_add_u32 v16, 65536, v2
    ds_read_b128 v[96:99], v16 offset:0
    v_mfma_f32_32x32x16_bf16 v[208:223], v[36:39], a[88:91], v[208:223]
    ds_read_b128 v[100:103], v16 offset:1024
    buffer_load_dwordx4 a[80:83], v2, s[12:15], s36 offen offset:1024 sc1
    v_mfma_f32_32x32x16_bf16 v[224:239], v[40:43], a[88:91], v[224:239]
    ds_read_b128 v[104:107], v16 offset:2048
    s_waitcnt lgkmcnt(3)
    v_mfma_f32_32x32x16_bf16 v[192:207], v[48:51], a[92:95], v[192:207]
    ds_read_b128 v[32:35], v16 offset:3072
    buffer_load_dwordx4 a[84:87], v2, s[12:15], s37 offen offset:1024 sc1
    v_mfma_f32_32x32x16_bf16 v[208:223], v[52:55], a[92:95], v[208:223]
    ds_read_b128 v[36:39], v16 offset:4096
    v_mfma_f32_32x32x16_bf16 v[224:239], v[56:59], a[92:95], v[224:239]
    ds_read_b128 v[40:43], v16 offset:5120
    s_waitcnt lgkmcnt(3)
    v_mfma_f32_32x32x16_bf16 v[192:207], v[96:99], a[96:99], v[192:207]
    ds_read_b128 v[48:51], v16 offset:6144
    v_mfma_f32_32x32x16_bf16 v[208:223], v[100:103], a[96:99], v[208:223]
    ds_read_b128 v[52:55], v16 offset:7168
    buffer_load_dwordx4 a[88:91], v2, s[12:15], s36 offen offset:2048 sc1
    s_add_u32 s36, s36, 7168
    v_mfma_f32_32x32x16_bf16 v[224:239], v[104:107], a[96:99], v[224:239]
    ds_read_b128 v[56:59], v16 offset:8192
    s_waitcnt lgkmcnt(3)
    v_mfma_f32_32x32x16_bf16 v[192:207], v[32:35], a[100:103], v[192:207]
    ds_read_b128 v[96:99], v16 offset:9216
    buffer_load_dwordx4 a[92:95], v2, s[12:15], s37 offen offset:2048 sc1
    s_add_u32 s37, s37, 7168
    v_mfma_f32_32x32x16_bf16 v[208:223], v[36:39], a[100:103], v[208:223]
    ds_read_b128 v[100:103], v16 offset:10240
    v_mfma_f32_32x32x16_bf16 v[224:239], v[40:43], a[100:103], v[224:239]
    ds_read_b128 v[104:107], v16 offset:11264
    s_barrier
    s_waitcnt lgkmcnt(3)
    v_mfma_f32_32x32x16_bf16 v[192:207], v[48:51], a[104:107], v[192:207]
    v_add_u32 v16, 81920, v2
    ds_read_b128 v[32:35], v16 offset:0
    v_mfma_f32_32x32x16_bf16 v[208:223], v[52:55], a[104:107], v[208:223]
    ds_read_b128 v[36:39], v16 offset:1024
    v_mfma_f32_32x32x16_bf16 v[224:239], v[56:59], a[104:107], v[224:239]
    ds_read_b128 v[40:43], v16 offset:2048
    s_waitcnt lgkmcnt(3)
    v_mfma_f32_32x32x16_bf16 v[192:207], v[96:99], a[108:111], v[192:207]
    ds_read_b128 v[48:51], v16 offset:3072
    v_mfma_f32_32x32x16_bf16 v[208:223], v[100:103], a[108:111], v[208:223]
    ds_read_b128 v[52:55], v16 offset:4096
    v_mfma_f32_32x32x16_bf16 v[224:239], v[104:107], a[108:111], v[224:239]
    ds_read_b128 v[56:59], v16 offset:5120
    s_waitcnt lgkmcnt(3)
    v_mfma_f32_32x32x16_bf16 v[192:207], v[32:35], a[112:115], v[192:207]
    ds_read_b128 v[96:99], v16 offset:6144
    v_mfma_f32_32x32x16_bf16 v[208:223], v[36:39], a[112:115], v[208:223]
    ds_read_b128 v[100:103], v16 offset:7168
    v_mfma_f32_32x32x16_bf16 v[224:239], v[40:43], a[112:115], v[224:239]
    ds_read_b128 v[104:107], v16 offset:8192
    s_waitcnt lgkmcnt(3)
    v_mfma_f32_32x32x16_bf16 v[192:207], v[48:51], a[116:119], v[192:207]
    ds_read_b128 v[32:35], v16 offset:9216
    v_mfma_f32_32x32x16_bf16 v[208:223], v[52:55], a[116:119], v[208:223]
    ds_read_b128 v[36:39], v16 offset:10240
    v_mfma_f32_32x32x16_bf16 v[224:239], v[56:59], a[116:119], v[224:239]
    ds_read_b128 v[40:43], v16 offset:11264
    s_waitcnt lgkmcnt(3)
    v_mfma_f32_32x32x16_bf16 v[192:207], v[96:99], a[120:123], v[192:207]
    v_mfma_f32_32x32x16_bf16 v[208:223], v[100:103], a[120:123], v[208:223]
    v_mfma_f32_32x32x16_bf16 v[224:239], v[104:107], a[120:123], v[224:239]
    s_waitcnt lgkmcnt(0)
    v_mfma_f32_32x32x16_bf16 v[192:207], v[32:35], a[124:127], v[192:207]
    v_mfma_f32_32x32x16_bf16 v[208:223], v[36:39], a[124:127], v[208:223]
    v_mfma_f32_32x32x16_bf16 v[224:239], v[40:43], a[124:127], v[224:239]
    s_nop 11
    v_mul_f32 v192, v192, v20
    v_mul_f32 v193, v193, v20
    v_mul_f32 v194, v194, v20
    v_mul_f32 v195, v195, v20
    v_mul_f32 v196, v196, v20
    v_mul_f32 v197, v197, v20
    v_mul_f32 v198, v198, v20
    v_mul_f32 v199, v199, v20
    v_exp_f32 v192, v192
    v_exp_f32 v193, v193
    v_exp_f32 v194, v194
    v_exp_f32 v195, v195
    v_exp_f32 v196, v196
    v_exp_f32 v197, v197
    v_exp_f32 v198, v198
    v_exp_f32 v199, v199
    v_fma_f32 v192, v192, v19, v19
    v_fma_f32 v193, v193, v19, v19
    v_fma_f32 v194, v194, v19, v19
    v_fma_f32 v195, v195, v19, v19
    v_fma_f32 v196, v196, v19, v19
    v_fma_f32 v197, v197, v19, v19
    v_fma_f32 v198, v198, v19, v19
    v_fma_f32 v199, v199, v19, v19
    v_rcp_f32 v192, v192
    v_rcp_f32 v193, v193
    v_rcp_f32 v194, v194
    v_rcp_f32 v195, v195
    v_rcp_f32 v196, v196
    v_rcp_f32 v197, v197
    v_rcp_f32 v198, v198
    v_rcp_f32 v199, v199
    v_mul_f32 v192, v192, v200
    v_mul_f32 v193, v193, v201
    v_mul_f32 v194, v194, v202
    v_mul_f32 v195, v195, v203
    v_mul_f32 v196, v196, v204
    v_mul_f32 v197, v197, v205
    v_mul_f32 v198, v198, v206
    v_mul_f32 v199, v199, v207
    v_cvt_pk_bf16_f32 v200, v192, v193
    v_cvt_pk_bf16_f32 v201, v194, v195
    v_cvt_pk_bf16_f32 v202, v196, v197
    v_cvt_pk_bf16_f32 v203, v198, v199
    buffer_store_dwordx4 v[200:203], v2, s[12:15], s34 offen offset:0 sc1
    v_mul_f32 v208, v208, v20
    v_mul_f32 v209, v209, v20
    v_mul_f32 v210, v210, v20
    v_mul_f32 v211, v211, v20
    v_mul_f32 v212, v212, v20
    v_mul_f32 v213, v213, v20
    v_mul_f32 v214, v214, v20
    v_mul_f32 v215, v215, v20
    v_exp_f32 v208, v208
    v_exp_f32 v209, v209
    v_exp_f32 v210, v210
    v_exp_f32 v211, v211
    v_exp_f32 v212, v212
    v_exp_f32 v213, v213
    v_exp_f32 v214, v214
    v_exp_f32 v215, v215
    v_fma_f32 v208, v208, v19, v19
    v_fma_f32 v209, v209, v19, v19
    v_fma_f32 v210, v210, v19, v19
    v_fma_f32 v211, v211, v19, v19
    v_fma_f32 v212, v212, v19, v19
    v_fma_f32 v213, v213, v19, v19
    v_fma_f32 v214, v214, v19, v19
    v_fma_f32 v215, v215, v19, v19
    v_rcp_f32 v208, v208
    v_rcp_f32 v209, v209
    v_rcp_f32 v210, v210
    v_rcp_f32 v211, v211
    v_rcp_f32 v212, v212
    v_rcp_f32 v213, v213
    v_rcp_f32 v214, v214
    v_rcp_f32 v215, v215
    v_mul_f32 v208, v208, v216
    v_mul_f32 v209, v209, v217
    v_mul_f32 v210, v210, v218
    v_mul_f32 v211, v211, v219
    v_mul_f32 v212, v212, v220
    v_mul_f32 v213, v213, v221
    v_mul_f32 v214, v214, v222
    v_mul_f32 v215, v215, v223
    v_cvt_pk_bf16_f32 v216, v208, v209
    v_cvt_pk_bf16_f32 v217, v210, v211
    v_cvt_pk_bf16_f32 v218, v212, v213
    v_cvt_pk_bf16_f32 v219, v214, v215
    buffer_store_dwordx4 v[216:219], v2, s[12:15], s34 offen offset:1024 sc1
    v_mul_f32 v224, v224, v20
    v_mul_f32 v225, v225, v20
    v_mul_f32 v226, v226, v20
    v_mul_f32 v227, v227, v20
    v_mul_f32 v228, v228, v20
    v_mul_f32 v229, v229, v20
    v_mul_f32 v230, v230, v20
    v_mul_f32 v231, v231, v20
    v_exp_f32 v224, v224
    v_exp_f32 v225, v225
    v_exp_f32 v226, v226
    v_exp_f32 v227, v227
    v_exp_f32 v228, v228
    v_exp_f32 v229, v229
    v_exp_f32 v230, v230
    v_exp_f32 v231, v231
    v_fma_f32 v224, v224, v19, v19
    v_fma_f32 v225, v225, v19, v19
    v_fma_f32 v226, v226, v19, v19
    v_fma_f32 v227, v227, v19, v19
    v_fma_f32 v228, v228, v19, v19
    v_fma_f32 v229, v229, v19, v19
    v_fma_f32 v230, v230, v19, v19
    v_fma_f32 v231, v231, v19, v19
    v_rcp_f32 v224, v224
    v_rcp_f32 v225, v225
    v_rcp_f32 v226, v226
    v_rcp_f32 v227, v227
    v_rcp_f32 v228, v228
    v_rcp_f32 v229, v229
    v_rcp_f32 v230, v230
    v_rcp_f32 v231, v231
    v_mul_f32 v224, v224, v232
    v_mul_f32 v225, v225, v233
    v_mul_f32 v226, v226, v234
    v_mul_f32 v227, v227, v235
    v_mul_f32 v228, v228, v236
    v_mul_f32 v229, v229, v237
    v_mul_f32 v230, v230, v238
    v_mul_f32 v231, v231, v239
    v_cvt_pk_bf16_f32 v232, v224, v225
    v_cvt_pk_bf16_f32 v233, v226, v227
    v_cvt_pk_bf16_f32 v234, v228, v229
    v_cvt_pk_bf16_f32 v235, v230, v231
    buffer_store_dwordx4 v[232:235], v2, s[12:15], s34 offen offset:2048 sc1
    s_mov_b32 s98, 604160
    buffer_load_dwordx2 v[14:15], v12, s[12:15], s98 offen sc1
    s_waitcnt vmcnt(0)
    s_barrier
    s_cmp_lg_u32 s4, 0
    s_cbranch_scc1 PB21
    s_lshl_b32 s98, s7, 3
    s_add_u32 s98, s98, 602112
    v_mov_b32 v252, s96
    v_mov_b32 v253, s97
    v_mov_b32 v254, 0
    s_mov_b64 exec, 1
    buffer_store_dwordx2 v[252:253], v254, s[12:15], s98 offen sc1
    s_mov_b64 exec, -1
PB21:
    s_xor_b32 s20, s4, 3
    s_mul_i32 s20, s20, 12288
    s_add_u32 s20, s20, 0
    v_add_u32 v4, s20, v2
    s_xor_b32 s20, s4, 2
    s_mul_i32 s20, s20, 12288
    s_add_u32 s20, s20, 0
    v_add_u32 v5, s20, v2
    s_xor_b32 s20, s4, 1
    s_mul_i32 s20, s20, 12288
    s_add_u32 s20, s20, 0
    v_add_u32 v6, s20, v2
    s_xor_b32 s20, s4, 0
    s_mul_i32 s20, s20, 12288
    s_add_u32 s20, s20, 0
    v_add_u32 v7, s20, v2
    s_lshr_b32 s22, s4, 1
    s_lshl_b32 s21, s3, 1
    s_add_u32 s22, s22, s21
    s_and_b32 s23, s4, 1
    s_lshl_b32 s21, s63, 1
    s_add_u32 s23, s23, s21
    v_and_b32 v10, 31, v1
    v_lshrrev_b32 v11, 5, v1
    v_lshlrev_b32 v10, 10, v10
    v_lshl_add_u32 v10, v11, 4, v10
    v_lshlrev_b32 v11, 4, v11
    s_load_dwordx2 s[24:25], s[0:1], 72
    s_mov_b32 s26, 2097152
    s_mov_b32 s27, 0x00020000
    s_lshl_b32 s29, s23, 7
    s_add_u32 s30, s29, 10240
    buffer_load_dwordx4 v[80:83], v11, s[12:15], s30 offen offset:0 sc1
    buffer_load_dwordx4 v[84:87], v11, s[12:15], s30 offen offset:32 sc1
    buffer_load_dwordx4 v[88:91], v11, s[12:15], s30 offen offset:64 sc1
    buffer_load_dwordx4 v[92:95], v11, s[12:15], s30 offen offset:96 sc1
    v_cmp_ne_u64 vcc, s[96:97], v[14:15]
    s_cmp_eq_u64 vcc, 0
    s_cbranch_scc1 F4AOK
    s_mov_b32 s99, 0
PL22:
    s_mov_b32 s98, 604160
    buffer_load_dwordx2 v[96:97], v12, s[12:15], s98 offen sc1
    s_add_u32 s99, s99, 1
    s_waitcnt vmcnt(0)
    v_cmp_ne_u64 vcc, s[96:97], v[96:97]
    s_cmp_eq_u64 vcc, 0
    s_cbranch_scc1 PD22
    s_sleep 2
    s_cmp_lt_u32 s99, 50000
    s_cbranch_scc1 PL22
PD22:
F4AOK:
    buffer_load_dwordx4 v[120:123], v2, s[12:15], s38 offen offset:0 sc1
    buffer_load_dwordx4 v[124:127], v2, s[12:15], s39 offen offset:0 sc1
    buffer_load_dwordx4 v[128:131], v2, s[12:15], s38 offen offset:1024 sc1
    buffer_load_dwordx4 v[132:135], v2, s[12:15], s39 offen offset:1024 sc1
    buffer_load_dwordx4 v[136:139], v2, s[12:15], s38 offen offset:2048 sc1
    buffer_load_dwordx4 v[140:143], v2, s[12:15], s39 offen offset:2048 sc1
    buffer_load_dwordx4 v[144:147], v2, s[12:15], s38 offen offset:3072 sc1
    s_add_u32 s38, s38, 7168
    buffer_load_dwordx4 v[148:151], v2, s[12:15], s39 offen offset:3072 sc1
    s_add_u32 s39, s39, 7168
    buffer_load_dwordx4 v[152:155], v2, s[12:15], s38 offen offset:0 sc1
    buffer_load_dwordx4 v[156:159], v2, s[12:15], s39 offen offset:0 sc1
    buffer_load_dwordx4 v[160:163], v2, s[12:15], s38 offen offset:1024 sc1
    buffer_load_dwordx4 v[164:167], v2, s[12:15], s39 offen offset:1024 sc1
    s_waitcnt vmcnt(11)
    v_mfma_f32_32x32x16_bf16 v[16:31], a[128:131], v[120:123], 0
    v_mfma_f32_32x32x16_bf16 v[32:47], a[132:135], v[120:123], 0
    buffer_load_dwordx4 v[168:171], v2, s[12:15], s38 offen offset:2048 sc1
    s_waitcnt vmcnt(11)
    v_mfma_f32_32x32x16_bf16 v[48:63], a[128:131], v[124:127], 0
    v_mfma_f32_32x32x16_bf16 v[64:79], a[132:135], v[124:127], 0
    buffer_load_dwordx4 v[172:175], v2, s[12:15], s39 offen offset:2048 sc1
    s_waitcnt vmcnt(11)
    v_mfma_f32_32x32x16_bf16 v[16:31], a[136:139], v[128:131], v[16:31]
    v_mfma_f32_32x32x16_bf16 v[32:47], a[140:143], v[128:131], v[32:47]
    buffer_load_dwordx4 v[176:179], v2, s[12:15], s38 offen offset:3072 sc1
    s_add_u32 s38, s38, 7168
    s_waitcnt vmcnt(11)
    v_mfma_f32_32x32x16_bf16 v[48:63], a[136:139], v[132:135], v[48:63]
    v_mfma_f32_32x32x16_bf16 v[64:79], a[140:143], v[132:135], v[64:79]
    buffer_load_dwordx4 v[180:183], v2, s[12:15], s39 offen offset:3072 sc1
    s_add_u32 s39, s39, 7168
    s_waitcnt vmcnt(11)
    v_mfma_f32_32x32x16_bf16 v[16:31], a[144:147], v[136:139], v[16:31]
    v_mfma_f32_32x32x16_bf16 v[32:47], a[148:151], v[136:139], v[32:47]
    buffer_load_dwordx4 v[184:187], v2, s[12:15], s38 offen offset:0 sc1
    s_waitcnt vmcnt(11)
    v_mfma_f32_32x32x16_bf16 v[48:63], a[144:147], v[140:143], v[48:63]
    v_mfma_f32_32x32x16_bf16 v[64:79], a[148:151], v[140:143], v[64:79]
    buffer_load_dwordx4 v[188:191], v2, s[12:15], s39 offen offset:0 sc1
    s_waitcnt vmcnt(11)
    v_mfma_f32_32x32x16_bf16 v[16:31], a[152:155], v[144:147], v[16:31]
    v_mfma_f32_32x32x16_bf16 v[32:47], a[156:159], v[144:147], v[32:47]
    buffer_load_dwordx4 v[192:195], v2, s[12:15], s38 offen offset:1024 sc1
    s_waitcnt vmcnt(11)
    v_mfma_f32_32x32x16_bf16 v[48:63], a[152:155], v[148:151], v[48:63]
    v_mfma_f32_32x32x16_bf16 v[64:79], a[156:159], v[148:151], v[64:79]
    buffer_load_dwordx4 v[196:199], v2, s[12:15], s39 offen offset:1024 sc1
    s_waitcnt vmcnt(11)
    v_mfma_f32_32x32x16_bf16 v[16:31], a[160:163], v[152:155], v[16:31]
    v_mfma_f32_32x32x16_bf16 v[32:47], a[164:167], v[152:155], v[32:47]
    s_mov_b32 s98, 602112
    buffer_load_dwordx2 v[14:15], v12, s[12:15], s98 offen sc1
    buffer_load_dwordx4 v[200:203], v2, s[12:15], s38 offen offset:2048 sc1
    s_waitcnt vmcnt(12)
    v_mfma_f32_32x32x16_bf16 v[48:63], a[160:163], v[156:159], v[48:63]
    v_mfma_f32_32x32x16_bf16 v[64:79], a[164:167], v[156:159], v[64:79]
    buffer_load_dwordx4 v[204:207], v2, s[12:15], s39 offen offset:2048 sc1
    s_waitcnt vmcnt(12)
    v_mfma_f32_32x32x16_bf16 v[16:31], a[168:171], v[160:163], v[16:31]
    v_mfma_f32_32x32x16_bf16 v[32:47], a[172:175], v[160:163], v[32:47]
    buffer_load_dwordx4 v[208:211], v2, s[12:15], s38 offen offset:3072 sc1
    s_add_u32 s38, s38, 7168
    s_waitcnt vmcnt(12)
    v_mfma_f32_32x32x16_bf16 v[48:63], a[168:171], v[164:167], v[48:63]
    v_mfma_f32_32x32x16_bf16 v[64:79], a[172:175], v[164:167], v[64:79]
    buffer_load_dwordx4 v[212:215], v2, s[12:15], s39 offen offset:3072 sc1
    s_add_u32 s39, s39, 7168
    s_waitcnt vmcnt(12)
    v_mfma_f32_32x32x16_bf16 v[16:31], a[176:179], v[168:171], v[16:31]
    v_mfma_f32_32x32x16_bf16 v[32:47], a[180:183], v[168:171], v[32:47]
    buffer_load_dwordx4 v[216:219], v2, s[12:15], s38 offen offset:0 sc1
    s_waitcnt vmcnt(12)
    v_mfma_f32_32x32x16_bf16 v[48:63], a[176:179], v[172:175], v[48:63]
    v_mfma_f32_32x32x16_bf16 v[64:79], a[180:183], v[172:175], v[64:79]
    buffer_load_dwordx4 v[220:223], v2, s[12:15], s39 offen offset:0 sc1
    s_waitcnt vmcnt(12)
    v_mfma_f32_32x32x16_bf16 v[16:31], a[184:187], v[176:179], v[16:31]
    v_mfma_f32_32x32x16_bf16 v[32:47], a[188:191], v[176:179], v[32:47]
    buffer_load_dwordx4 v[224:227], v2, s[12:15], s38 offen offset:1024 sc1
    s_waitcnt vmcnt(12)
    v_mfma_f32_32x32x16_bf16 v[48:63], a[184:187], v[180:183], v[48:63]
    v_mfma_f32_32x32x16_bf16 v[64:79], a[188:191], v[180:183], v[64:79]
    buffer_load_dwordx4 v[228:231], v2, s[12:15], s39 offen offset:1024 sc1
    s_waitcnt vmcnt(12)
    v_mfma_f32_32x32x16_bf16 v[16:31], a[192:195], v[184:187], v[16:31]
    v_mfma_f32_32x32x16_bf16 v[32:47], a[196:199], v[184:187], v[32:47]
    buffer_load_dwordx4 v[232:235], v2, s[12:15], s38 offen offset:2048 sc1
    s_waitcnt vmcnt(12)
    v_mfma_f32_32x32x16_bf16 v[48:63], a[192:195], v[188:191], v[48:63]
    v_mfma_f32_32x32x16_bf16 v[64:79], a[196:199], v[188:191], v[64:79]
    buffer_load_dwordx4 v[236:239], v2, s[12:15], s39 offen offset:2048 sc1
    s_waitcnt vmcnt(12)
    v_mfma_f32_32x32x16_bf16 v[16:31], a[200:203], v[192:195], v[16:31]
    v_mfma_f32_32x32x16_bf16 v[32:47], a[204:207], v[192:195], v[32:47]
    buffer_load_dwordx4 v[240:243], v2, s[12:15], s38 offen offset:3072 sc1
    s_add_u32 s38, s38, 4294949888
    s_waitcnt vmcnt(12)
    v_mfma_f32_32x32x16_bf16 v[48:63], a[200:203], v[196:199], v[48:63]
    v_mfma_f32_32x32x16_bf16 v[64:79], a[204:207], v[196:199], v[64:79]
    buffer_load_dwordx4 v[244:247], v2, s[12:15], s39 offen offset:3072 sc1
    s_add_u32 s39, s39, 4294949888
    s_waitcnt vmcnt(12)
    v_cmp_ne_u64 vcc, s[96:97], v[14:15]
    s_cmp_eq_u64 vcc, 0
    s_cbranch_scc1 F4OK
    s_mov_b32 s99, 0
PL23:
    s_mov_b32 s98, 602112
    buffer_load_dwordx2 v[96:97], v12, s[12:15], s98 offen sc1
    s_add_u32 s99, s99, 1
    s_waitcnt vmcnt(0)
    v_cmp_ne_u64 vcc, s[96:97], v[96:97]
    s_cmp_eq_u64 vcc, 0
    s_cbranch_scc1 PD23
    s_sleep 2
    s_cmp_lt_u32 s99, 50000
    s_cbranch_scc1 PL23
PD23:
F4OK:
    s_waitcnt vmcnt(11)
    v_mfma_f32_32x32x16_bf16 v[16:31], a[208:211], v[200:203], v[16:31]
    v_mfma_f32_32x32x16_bf16 v[32:47], a[212:215], v[200:203], v[32:47]
    buffer_load_dwordx4 v[248:251], v2, s[12:15], s38 offen offset:0 sc1
    s_waitcnt vmcnt(11)
    v_mfma_f32_32x32x16_bf16 v[48:63], a[208:211], v[204:207], v[48:63]
    v_mfma_f32_32x32x16_bf16 v[64:79], a[212:215], v[204:207], v[64:79]
    buffer_load_dwordx4 v[252:255], v2, s[12:15], s39 offen offset:0 sc1
    s_waitcnt vmcnt(11)
    v_mfma_f32_32x32x16_bf16 v[16:31], a[216:219], v[208:211], v[16:31]
    v_mfma_f32_32x32x16_bf16 v[32:47], a[220:223], v[208:211], v[32:47]
    buffer_load_dwordx4 v[120:123], v2, s[12:15], s38 offen offset:1024 sc1
    s_waitcnt vmcnt(11)
    v_mfma_f32_32x32x16_bf16 v[48:63], a[216:219], v[212:215], v[48:63]
    v_mfma_f32_32x32x16_bf16 v[64:79], a[220:223], v[212:215], v[64:79]
    buffer_load_dwordx4 v[124:127], v2, s[12:15], s39 offen offset:1024 sc1
    s_waitcnt vmcnt(11)
    v_mfma_f32_32x32x16_bf16 v[16:31], a[224:227], v[216:219], v[16:31]
    v_mfma_f32_32x32x16_bf16 v[32:47], a[228:231], v[216:219], v[32:47]
    buffer_load_dwordx4 v[128:131], v2, s[12:15], s38 offen offset:2048 sc1
    s_add_u32 s38, s38, 7168
    s_waitcnt vmcnt(11)
    v_mfma_f32_32x32x16_bf16 v[48:63], a[224:227], v[220:223], v[48:63]
    v_mfma_f32_32x32x16_bf16 v[64:79], a[228:231], v[220:223], v[64:79]
    buffer_load_dwordx4 v[132:135], v2, s[12:15], s39 offen offset:2048 sc1
    s_add_u32 s39, s39, 7168
    s_waitcnt vmcnt(11)
    v_mfma_f32_32x32x16_bf16 v[16:31], a[232:235], v[224:227], v[16:31]
    v_mfma_f32_32x32x16_bf16 v[32:47], a[236:239], v[224:227], v[32:47]
    buffer_load_dwordx4 v[136:139], v2, s[12:15], s38 offen offset:0 sc1
    s_waitcnt vmcnt(11)
    v_mfma_f32_32x32x16_bf16 v[48:63], a[232:235], v[228:231], v[48:63]
    v_mfma_f32_32x32x16_bf16 v[64:79], a[236:239], v[228:231], v[64:79]
    buffer_load_dwordx4 v[140:143], v2, s[12:15], s39 offen offset:0 sc1
    s_waitcnt vmcnt(11)
    v_mfma_f32_32x32x16_bf16 v[16:31], a[240:243], v[232:235], v[16:31]
    v_mfma_f32_32x32x16_bf16 v[32:47], a[244:247], v[232:235], v[32:47]
    buffer_load_dwordx4 v[144:147], v2, s[12:15], s38 offen offset:1024 sc1
    s_waitcnt vmcnt(11)
    v_mfma_f32_32x32x16_bf16 v[48:63], a[240:243], v[236:239], v[48:63]
    v_mfma_f32_32x32x16_bf16 v[64:79], a[244:247], v[236:239], v[64:79]
    buffer_load_dwordx4 v[148:151], v2, s[12:15], s39 offen offset:1024 sc1
    s_waitcnt vmcnt(11)
    v_mfma_f32_32x32x16_bf16 v[16:31], a[248:251], v[240:243], v[16:31]
    v_mfma_f32_32x32x16_bf16 v[32:47], a[252:255], v[240:243], v[32:47]
    buffer_load_dwordx4 v[152:155], v2, s[12:15], s38 offen offset:2048 sc1
    s_add_u32 s38, s38, 7168
    s_waitcnt vmcnt(11)
    v_mfma_f32_32x32x16_bf16 v[48:63], a[248:251], v[244:247], v[48:63]
    v_mfma_f32_32x32x16_bf16 v[64:79], a[252:255], v[244:247], v[64:79]
    buffer_load_dwordx4 v[156:159], v2, s[12:15], s39 offen offset:2048 sc1
    s_add_u32 s39, s39, 7168
    s_waitcnt vmcnt(11)
    v_mfma_f32_32x32x16_bf16 v[16:31], a[0:3], v[248:251], v[16:31]
    v_mfma_f32_32x32x16_bf16 v[32:47], a[4:7], v[248:251], v[32:47]
    buffer_load_dwordx4 v[160:163], v2, s[12:15], s38 offen offset:0 sc1
    s_waitcnt vmcnt(11)
    v_mfma_f32_32x32x16_bf16 v[48:63], a[0:3], v[252:255], v[48:63]
    v_mfma_f32_32x32x16_bf16 v[64:79], a[4:7], v[252:255], v[64:79]
    buffer_load_dwordx4 v[164:167], v2, s[12:15], s39 offen offset:0 sc1
    s_waitcnt vmcnt(11)
    v_mfma_f32_32x32x16_bf16 v[16:31], a[8:11], v[120:123], v[16:31]
    v_mfma_f32_32x32x16_bf16 v[32:47], a[12:15], v[120:123], v[32:47]
    buffer_load_dwordx4 v[168:171], v2, s[12:15], s38 offen offset:1024 sc1
    s_waitcnt vmcnt(11)
    v_mfma_f32_32x32x16_bf16 v[48:63], a[8:11], v[124:127], v[48:63]
    v_mfma_f32_32x32x16_bf16 v[64:79], a[12:15], v[124:127], v[64:79]
    buffer_load_dwordx4 v[172:175], v2, s[12:15], s39 offen offset:1024 sc1
    s_waitcnt vmcnt(11)
    v_mfma_f32_32x32x16_bf16 v[16:31], a[16:19], v[128:131], v[16:31]
    v_mfma_f32_32x32x16_bf16 v[32:47], a[20:23], v[128:131], v[32:47]
    buffer_load_dwordx4 v[176:179], v2, s[12:15], s38 offen offset:2048 sc1
    s_add_u32 s38, s38, 7168
    s_waitcnt vmcnt(11)
    v_mfma_f32_32x32x16_bf16 v[48:63], a[16:19], v[132:135], v[48:63]
    v_mfma_f32_32x32x16_bf16 v[64:79], a[20:23], v[132:135], v[64:79]
    buffer_load_dwordx4 v[180:183], v2, s[12:15], s39 offen offset:2048 sc1
    s_add_u32 s39, s39, 7168
    s_waitcnt vmcnt(11)
    v_mfma_f32_32x32x16_bf16 v[16:31], a[24:27], v[136:139], v[16:31]
    v_mfma_f32_32x32x16_bf16 v[32:47], a[28:31], v[136:139], v[32:47]
    buffer_load_dwordx4 v[184:187], v2, s[12:15], s38 offen offset:0 sc1
    s_waitcnt vmcnt(11)
    v_mfma_f32_32x32x16_bf16 v[48:63], a[24:27], v[140:143], v[48:63]
    v_mfma_f32_32x32x16_bf16 v[64:79], a[28:31], v[140:143], v[64:79]
    buffer_load_dwordx4 v[188:191], v2, s[12:15], s39 offen offset:0 sc1
    s_waitcnt vmcnt(11)
    v_mfma_f32_32x32x16_bf16 v[16:31], a[32:35], v[144:147], v[16:31]
    v_mfma_f32_32x32x16_bf16 v[32:47], a[36:39], v[144:147], v[32:47]
    buffer_load_dwordx4 v[192:195], v2, s[12:15], s38 offen offset:1024 sc1
    s_waitcnt vmcnt(11)
    v_mfma_f32_32x32x16_bf16 v[48:63], a[32:35], v[148:151], v[48:63]
    v_mfma_f32_32x32x16_bf16 v[64:79], a[36:39], v[148:151], v[64:79]
    buffer_load_dwordx4 v[196:199], v2, s[12:15], s39 offen offset:1024 sc1
    s_waitcnt vmcnt(11)
    v_mfma_f32_32x32x16_bf16 v[16:31], a[40:43], v[152:155], v[16:31]
    v_mfma_f32_32x32x16_bf16 v[32:47], a[44:47], v[152:155], v[32:47]
    buffer_load_dwordx4 v[200:203], v2, s[12:15], s38 offen offset:2048 sc1
    s_add_u32 s38, s38, 7168
    s_waitcnt vmcnt(11)
    v_mfma_f32_32x32x16_bf16 v[48:63], a[40:43], v[156:159], v[48:63]
    v_mfma_f32_32x32x16_bf16 v[64:79], a[44:47], v[156:159], v[64:79]
    buffer_load_dwordx4 v[204:207], v2, s[12:15], s39 offen offset:2048 sc1
    s_add_u32 s39, s39, 7168
    s_waitcnt vmcnt(11)
    v_mfma_f32_32x32x16_bf16 v[16:31], a[48:51], v[160:163], v[16:31]
    v_mfma_f32_32x32x16_bf16 v[32:47], a[52:55], v[160:163], v[32:47]
    s_waitcnt vmcnt(10)
    v_mfma_f32_32x32x16_bf16 v[48:63], a[48:51], v[164:167], v[48:63]
    v_mfma_f32_32x32x16_bf16 v[64:79], a[52:55], v[164:167], v[64:79]
    s_waitcnt vmcnt(9)
    v_mfma_f32_32x32x16_bf16 v[16:31], a[56:59], v[168:171], v[16:31]
    v_mfma_f32_32x32x16_bf16 v[32:47], a[60:63], v[168:171], v[32:47]
    s_waitcnt vmcnt(8)
    v_mfma_f32_32x32x16_bf16 v[48:63], a[56:59], v[172:175], v[48:63]
    v_mfma_f32_32x32x16_bf16 v[64:79], a[60:63], v[172:175], v[64:79]
    s_waitcnt vmcnt(7)
    v_mfma_f32_32x32x16_bf16 v[16:31], a[64:67], v[176:179], v[16:31]
    s_waitcnt vmcnt(5)
    v_mfma_f32_32x32x16_bf16 v[16:31], a[72:75], v[184:187], v[16:31]
    s_waitcnt vmcnt(3)
    v_mfma_f32_32x32x16_bf16 v[16:31], a[80:83], v[192:195], v[16:31]
    s_waitcnt vmcnt(1)
    v_mfma_f32_32x32x16_bf16 v[16:31], a[88:91], v[200:203], v[16:31]
    v_mfma_f32_32x32x16_bf16 v[32:47], a[68:71], v[176:179], v[32:47]
    s_nop 7
    v_mfma_f32_32x32x16_bf16 v[32:47], a[76:79], v[184:187], v[32:47]
    s_nop 1
    ds_write_b128 v7, v[16:19] offset:0
    ds_write_b128 v7, v[20:23] offset:1024
    v_mfma_f32_32x32x16_bf16 v[32:47], a[84:87], v[192:195], v[32:47]
    ds_write_b128 v7, v[24:27] offset:2048
    ds_write_b128 v7, v[28:31] offset:3072
    v_mfma_f32_32x32x16_bf16 v[32:47], a[92:95], v[200:203], v[32:47]
    v_mfma_f32_32x32x16_bf16 v[48:63], a[64:67], v[180:183], v[48:63]
    s_nop 7
    v_mfma_f32_32x32x16_bf16 v[48:63], a[72:75], v[188:191], v[48:63]
    s_nop 1
    ds_write_b128 v7, v[32:35] offset:4096
    ds_write_b128 v7, v[36:39] offset:5120
    v_mfma_f32_32x32x16_bf16 v[48:63], a[80:83], v[196:199], v[48:63]
    ds_write_b128 v7, v[40:43] offset:6144
    ds_write_b128 v7, v[44:47] offset:7168
    s_waitcnt vmcnt(0)
    v_mfma_f32_32x32x16_bf16 v[48:63], a[88:91], v[204:207], v[48:63]
    v_mfma_f32_32x32x16_bf16 v[64:79], a[68:71], v[180:183], v[64:79]
    s_nop 7
    v_mfma_f32_32x32x16_bf16 v[64:79], a[76:79], v[188:191], v[64:79]
    s_nop 1
    ds_write_b128 v7, v[48:51] offset:8192
    ds_write_b128 v7, v[52:55] offset:9216
    v_mfma_f32_32x32x16_bf16 v[64:79], a[84:87], v[196:199], v[64:79]
    ds_write_b128 v7, v[56:59] offset:10240
    ds_write_b128 v7, v[60:63] offset:11264
    v_mfma_f32_32x32x16_bf16 v[64:79], a[92:95], v[204:207], v[64:79]
    s_waitcnt lgkmcnt(0)
    s_barrier
    ds_read_b128 v[16:19], v4 offset:0
    ds_read_b128 v[20:23], v4 offset:1024
    ds_read_b128 v[24:27], v4 offset:2048
    ds_read_b128 v[28:31], v4 offset:3072
    ds_read_b128 v[32:35], v5 offset:4096
    ds_read_b128 v[36:39], v5 offset:5120
    ds_read_b128 v[40:43], v5 offset:6144
    ds_read_b128 v[44:47], v5 offset:7168
    ds_read_b128 v[48:51], v6 offset:8192
    ds_read_b128 v[52:55], v6 offset:9216
    ds_read_b128 v[56:59], v6 offset:10240
    ds_read_b128 v[60:63], v6 offset:11264
    s_waitcnt lgkmcnt(11)
    v_pk_add_f32 v[64:65], v[64:65], v[16:17]
    v_pk_add_f32 v[66:67], v[66:67], v[18:19]
    s_waitcnt lgkmcnt(10)
    v_pk_add_f32 v[68:69], v[68:69], v[20:21]
    v_pk_add_f32 v[70:71], v[70:71], v[22:23]
    s_waitcnt lgkmcnt(9)
    v_pk_add_f32 v[72:73], v[72:73], v[24:25]
    v_pk_add_f32 v[74:75], v[74:75], v[26:27]
    s_waitcnt lgkmcnt(8)
    v_pk_add_f32 v[76:77], v[76:77], v[28:29]
    v_pk_add_f32 v[78:79], v[78:79], v[30:31]
    s_waitcnt lgkmcnt(7)
    v_pk_add_f32 v[64:65], v[64:65], v[32:33]
    v_pk_add_f32 v[66:67], v[66:67], v[34:35]
    s_waitcnt lgkmcnt(6)
    v_pk_add_f32 v[68:69], v[68:69], v[36:37]
    v_pk_add_f32 v[70:71], v[70:71], v[38:39]
    s_waitcnt lgkmcnt(5)
    v_pk_add_f32 v[72:73], v[72:73], v[40:41]
    v_pk_add_f32 v[74:75], v[74:75], v[42:43]
    s_waitcnt lgkmcnt(4)
    v_pk_add_f32 v[76:77], v[76:77], v[44:45]
    v_pk_add_f32 v[78:79], v[78:79], v[46:47]
    s_waitcnt lgkmcnt(3)
    v_pk_add_f32 v[64:65], v[64:65], v[48:49]
    v_pk_add_f32 v[66:67], v[66:67], v[50:51]
    s_waitcnt lgkmcnt(2)
    v_pk_add_f32 v[68:69], v[68:69], v[52:53]
    v_pk_add_f32 v[70:71], v[70:71], v[54:55]
    s_waitcnt lgkmcnt(1)
    v_pk_add_f32 v[72:73], v[72:73], v[56:57]
    v_pk_add_f32 v[74:75], v[74:75], v[58:59]
    s_waitcnt lgkmcnt(0)
    v_pk_add_f32 v[76:77], v[76:77], v[60:61]
    v_pk_add_f32 v[78:79], v[78:79], v[62:63]
    v_lshlrev_b32 v14, 16, v112
    v_and_b32 v15, 0xffff0000, v112
    v_fma_f32 v14, v64, v80, v14
    v_fma_f32 v15, v65, v81, v15
    v_cvt_pk_bf16_f32 v16, v14, v15
    v_lshlrev_b32 v14, 16, v113
    v_and_b32 v15, 0xffff0000, v113
    v_fma_f32 v14, v66, v82, v14
    v_fma_f32 v15, v67, v83, v15
    v_cvt_pk_bf16_f32 v17, v14, v15
    v_lshlrev_b32 v14, 16, v114
    v_and_b32 v15, 0xffff0000, v114
    v_fma_f32 v14, v68, v84, v14
    v_fma_f32 v15, v69, v85, v15
    v_cvt_pk_bf16_f32 v18, v14, v15
    v_lshlrev_b32 v14, 16, v115
    v_and_b32 v15, 0xffff0000, v115
    v_fma_f32 v14, v70, v86, v14
    v_fma_f32 v15, v71, v87, v15
    v_cvt_pk_bf16_f32 v19, v14, v15
    v_lshlrev_b32 v14, 16, v116
    v_and_b32 v15, 0xffff0000, v116
    v_fma_f32 v14, v72, v88, v14
    v_fma_f32 v15, v73, v89, v15
    v_cvt_pk_bf16_f32 v20, v14, v15
    v_lshlrev_b32 v14, 16, v117
    v_and_b32 v15, 0xffff0000, v117
    v_fma_f32 v14, v74, v90, v14
    v_fma_f32 v15, v75, v91, v15
    v_cvt_pk_bf16_f32 v21, v14, v15
    v_lshlrev_b32 v14, 16, v118
    v_and_b32 v15, 0xffff0000, v118
    v_fma_f32 v14, v76, v92, v14
    v_fma_f32 v15, v77, v93, v15
    v_cvt_pk_bf16_f32 v22, v14, v15
    v_lshlrev_b32 v14, 16, v119
    v_and_b32 v15, 0xffff0000, v119
    v_fma_f32 v14, v78, v94, v14
    v_fma_f32 v15, v79, v95, v15
    v_cvt_pk_bf16_f32 v23, v14, v15
    s_lshl_b32 s28, s22, 15
    s_lshl_b32 s29, s23, 6
    s_add_u32 s28, s28, s29
    v_permlane32_swap_b32 v16, v18
    v_permlane32_swap_b32 v17, v19
    v_permlane32_swap_b32 v20, v22
    v_permlane32_swap_b32 v21, v23
    buffer_store_dwordx4 v[16:19], v10, s[24:27], s28 offen
    buffer_store_dwordx4 v[20:23], v10, s[24:27], s28 offen offset:32
PK_END:
    s_endpgm
P2F00:
    v_mov_b32 v64, 4048155338
    v_mov_b32 v65, 4048155338
    v_mov_b32 v66, 4048155338
    v_mov_b32 v67, 4048155338
    v_mov_b32 v68, 4048155338
    v_mov_b32 v69, 4048155338
    v_mov_b32 v70, 4048155338
    v_mov_b32 v71, 4048155338
    v_mov_b32 v72, 4048155338
    v_mov_b32 v73, 4048155338
    v_mov_b32 v74, 4048155338
    v_mov_b32 v75, 4048155338
    v_mov_b32 v76, 4048155338
    v_mov_b32 v77, 4048155338
    v_mov_b32 v78, 4048155338
    v_mov_b32 v79, 4048155338
    s_branch P2N00
P2F01:
    v_mov_b32 v80, 4048155338
    v_mov_b32 v81, 4048155338
    v_mov_b32 v82, 4048155338
    v_mov_b32 v83, 4048155338
    v_mov_b32 v84, 4048155338
    v_mov_b32 v85, 4048155338
    v_mov_b32 v86, 4048155338
    v_mov_b32 v87, 4048155338
    v_mov_b32 v88, 4048155338
    v_mov_b32 v89, 4048155338
    v_mov_b32 v90, 4048155338
    v_mov_b32 v91, 4048155338
    v_mov_b32 v92, 4048155338
    v_mov_b32 v93, 4048155338
    v_mov_b32 v94, 4048155338
    v_mov_b32 v95, 4048155338
    s_branch P2N01
P2F02:
    v_mov_b32 v96, 4048155338
    v_mov_b32 v97, 4048155338
    v_mov_b32 v98, 4048155338
    v_mov_b32 v99, 4048155338
    v_mov_b32 v100, 4048155338
    v_mov_b32 v101, 4048155338
    v_mov_b32 v102, 4048155338
    v_mov_b32 v103, 4048155338
    v_mov_b32 v104, 4048155338
    v_mov_b32 v105, 4048155338
    v_mov_b32 v106, 4048155338
    v_mov_b32 v107, 4048155338
    v_mov_b32 v108, 4048155338
    v_mov_b32 v109, 4048155338
    v_mov_b32 v110, 4048155338
    v_mov_b32 v111, 4048155338
    s_branch P2N02
P2F03:
    v_mov_b32 v112, 4048155338
    v_mov_b32 v113, 4048155338
    v_mov_b32 v114, 4048155338
    v_mov_b32 v115, 4048155338
    v_mov_b32 v116, 4048155338
    v_mov_b32 v117, 4048155338
    v_mov_b32 v118, 4048155338
    v_mov_b32 v119, 4048155338
    v_mov_b32 v120, 4048155338
    v_mov_b32 v121, 4048155338
    v_mov_b32 v122, 4048155338
    v_mov_b32 v123, 4048155338
    v_mov_b32 v124, 4048155338
    v_mov_b32 v125, 4048155338
    v_mov_b32 v126, 4048155338
    v_mov_b32 v127, 4048155338
    s_branch P2N03
P2F04:
    v_mov_b32 v128, 4048155338
    v_mov_b32 v129, 4048155338
    v_mov_b32 v130, 4048155338
    v_mov_b32 v131, 4048155338
    v_mov_b32 v132, 4048155338
    v_mov_b32 v133, 4048155338
    v_mov_b32 v134, 4048155338
    v_mov_b32 v135, 4048155338
    v_mov_b32 v136, 4048155338
    v_mov_b32 v137, 4048155338
    v_mov_b32 v138, 4048155338
    v_mov_b32 v139, 4048155338
    v_mov_b32 v140, 4048155338
    v_mov_b32 v141, 4048155338
    v_mov_b32 v142, 4048155338
    v_mov_b32 v143, 4048155338
    s_branch P2N04
P2F05:
    v_mov_b32 v144, 4048155338
    v_mov_b32 v145, 4048155338
    v_mov_b32 v146, 4048155338
    v_mov_b32 v147, 4048155338
    v_mov_b32 v148, 4048155338
    v_mov_b32 v149, 4048155338
    v_mov_b32 v150, 4048155338
    v_mov_b32 v151, 4048155338
    v_mov_b32 v152, 4048155338
    v_mov_b32 v153, 4048155338
    v_mov_b32 v154, 4048155338
    v_mov_b32 v155, 4048155338
    v_mov_b32 v156, 4048155338
    v_mov_b32 v157, 4048155338
    v_mov_b32 v158, 4048155338
    v_mov_b32 v159, 4048155338
    s_branch P2N05
P2F06:
    v_mov_b32 v160, 4048155338
    v_mov_b32 v161, 4048155338
    v_mov_b32 v162, 4048155338
    v_mov_b32 v163, 4048155338
    v_mov_b32 v164, 4048155338
    v_mov_b32 v165, 4048155338
    v_mov_b32 v166, 4048155338
    v_mov_b32 v167, 4048155338
    v_mov_b32 v168, 4048155338
    v_mov_b32 v169, 4048155338
    v_mov_b32 v170, 4048155338
    v_mov_b32 v171, 4048155338
    v_mov_b32 v172, 4048155338
    v_mov_b32 v173, 4048155338
    v_mov_b32 v174, 4048155338
    v_mov_b32 v175, 4048155338
    s_branch P2N06
P2F07:
    v_mov_b32 v176, 4048155338
    v_mov_b32 v177, 4048155338
    v_mov_b32 v178, 4048155338
    v_mov_b32 v179, 4048155338
    v_mov_b32 v180, 4048155338
    v_mov_b32 v181, 4048155338
    v_mov_b32 v182, 4048155338
    v_mov_b32 v183, 4048155338
    v_mov_b32 v184, 4048155338
    v_mov_b32 v185, 4048155338
    v_mov_b32 v186, 4048155338
    v_mov_b32 v187, 4048155338
    v_mov_b32 v188, 4048155338
    v_mov_b32 v189, 4048155338
    v_mov_b32 v190, 4048155338
    v_mov_b32 v191, 4048155338
    s_branch P2N07
P2F10:
    v_mov_b32 v64, 4048155338
    v_mov_b32 v65, 4048155338
    v_mov_b32 v66, 4048155338
    v_mov_b32 v67, 4048155338
    v_mov_b32 v68, 4048155338
    v_mov_b32 v69, 4048155338
    v_mov_b32 v70, 4048155338
    v_mov_b32 v71, 4048155338
    v_mov_b32 v72, 4048155338
    v_mov_b32 v73, 4048155338
    v_mov_b32 v74, 4048155338
    v_mov_b32 v75, 4048155338
    v_mov_b32 v76, 4048155338
    v_mov_b32 v77, 4048155338
    v_mov_b32 v78, 4048155338
    v_mov_b32 v79, 4048155338
    s_branch P2N10
P2F11:
    v_mov_b32 v80, 4048155338
    v_mov_b32 v81, 4048155338
    v_mov_b32 v82, 4048155338
    v_mov_b32 v83, 4048155338
    v_mov_b32 v84, 4048155338
    v_mov_b32 v85, 4048155338
    v_mov_b32 v86, 4048155338
    v_mov_b32 v87, 4048155338
    v_mov_b32 v88, 4048155338
    v_mov_b32 v89, 4048155338
    v_mov_b32 v90, 4048155338
    v_mov_b32 v91, 4048155338
    v_mov_b32 v92, 4048155338
    v_mov_b32 v93, 4048155338
    v_mov_b32 v94, 4048155338
    v_mov_b32 v95, 4048155338
    s_branch P2N11
P2F12:
    v_mov_b32 v96, 4048155338
    v_mov_b32 v97, 4048155338
    v_mov_b32 v98, 4048155338
    v_mov_b32 v99, 4048155338
    v_mov_b32 v100, 4048155338
    v_mov_b32 v101, 4048155338
    v_mov_b32 v102, 4048155338
    v_mov_b32 v103, 4048155338
    v_mov_b32 v104, 4048155338
    v_mov_b32 v105, 4048155338
    v_mov_b32 v106, 4048155338
    v_mov_b32 v107, 4048155338
    v_mov_b32 v108, 4048155338
    v_mov_b32 v109, 4048155338
    v_mov_b32 v110, 4048155338
    v_mov_b32 v111, 4048155338
    s_branch P2N12
P2F13:
    v_mov_b32 v112, 4048155338
    v_mov_b32 v113, 4048155338
    v_mov_b32 v114, 4048155338
    v_mov_b32 v115, 4048155338
    v_mov_b32 v116, 4048155338
    v_mov_b32 v117, 4048155338
    v_mov_b32 v118, 4048155338
    v_mov_b32 v119, 4048155338
    v_mov_b32 v120, 4048155338
    v_mov_b32 v121, 4048155338
    v_mov_b32 v122, 4048155338
    v_mov_b32 v123, 4048155338
    v_mov_b32 v124, 4048155338
    v_mov_b32 v125, 4048155338
    v_mov_b32 v126, 4048155338
    v_mov_b32 v127, 4048155338
    s_branch P2N13
P2F14:
    v_mov_b32 v128, 4048155338
    v_mov_b32 v129, 4048155338
    v_mov_b32 v130, 4048155338
    v_mov_b32 v131, 4048155338
    v_mov_b32 v132, 4048155338
    v_mov_b32 v133, 4048155338
    v_mov_b32 v134, 4048155338
    v_mov_b32 v135, 4048155338
    v_mov_b32 v136, 4048155338
    v_mov_b32 v137, 4048155338
    v_mov_b32 v138, 4048155338
    v_mov_b32 v139, 4048155338
    v_mov_b32 v140, 4048155338
    v_mov_b32 v141, 4048155338
    v_mov_b32 v142, 4048155338
    v_mov_b32 v143, 4048155338
    s_branch P2N14
P2F15:
    v_mov_b32 v144, 4048155338
    v_mov_b32 v145, 4048155338
    v_mov_b32 v146, 4048155338
    v_mov_b32 v147, 4048155338
    v_mov_b32 v148, 4048155338
    v_mov_b32 v149, 4048155338
    v_mov_b32 v150, 4048155338
    v_mov_b32 v151, 4048155338
    v_mov_b32 v152, 4048155338
    v_mov_b32 v153, 4048155338
    v_mov_b32 v154, 4048155338
    v_mov_b32 v155, 4048155338
    v_mov_b32 v156, 4048155338
    v_mov_b32 v157, 4048155338
    v_mov_b32 v158, 4048155338
    v_mov_b32 v159, 4048155338
    s_branch P2N15
P2F16:
    v_mov_b32 v160, 4048155338
    v_mov_b32 v161, 4048155338
    v_mov_b32 v162, 4048155338
    v_mov_b32 v163, 4048155338
    v_mov_b32 v164, 4048155338
    v_mov_b32 v165, 4048155338
    v_mov_b32 v166, 4048155338
    v_mov_b32 v167, 4048155338
    v_mov_b32 v168, 4048155338
    v_mov_b32 v169, 4048155338
    v_mov_b32 v170, 4048155338
    v_mov_b32 v171, 4048155338
    v_mov_b32 v172, 4048155338
    v_mov_b32 v173, 4048155338
    v_mov_b32 v174, 4048155338
    v_mov_b32 v175, 4048155338
    s_branch P2N16
P2F17:
    v_mov_b32 v176, 4048155338
    v_mov_b32 v177, 4048155338
    v_mov_b32 v178, 4048155338
    v_mov_b32 v179, 4048155338
    v_mov_b32 v180, 4048155338
    v_mov_b32 v181, 4048155338
    v_mov_b32 v182, 4048155338
    v_mov_b32 v183, 4048155338
    v_mov_b32 v184, 4048155338
    v_mov_b32 v185, 4048155338
    v_mov_b32 v186, 4048155338
    v_mov_b32 v187, 4048155338
    v_mov_b32 v188, 4048155338
    v_mov_b32 v189, 4048155338
    v_mov_b32 v190, 4048155338
    v_mov_b32 v191, 4048155338
    s_branch P2N17
PK_LAST:
    s_endpgm

.section .rodata,"a"
.p2align 6
.amdhsa_kernel adaLN_cond__sliding_block__glu_gated_glu__prompt_kernel
  .amdhsa_next_free_vgpr 512
  .amdhsa_next_free_sgpr 102
  .amdhsa_accum_offset 256
  .amdhsa_group_segment_fixed_size 0
  .amdhsa_kernarg_size 96
  .amdhsa_user_sgpr_count 2
  .amdhsa_user_sgpr_kernarg_segment_ptr 1
  .amdhsa_system_sgpr_workgroup_id_x 1
.end_amdhsa_kernel
```
